```python
import torch

def _softmax(x, axis=-1):
    return torch.softmax(x, dim=axis)
def _gelu(x):
    return torch.nn.functional.gelu(x, approximate="tanh")
def _silu(x):
    return torch.nn.functional.silu(x)
def _sigmoid(x):
    return torch.sigmoid(x)
def _layernorm(x, axis=-1, eps=1e-5):
    m = x.mean(dim=axis, keepdim=True)
    v = x.var(dim=axis, keepdim=True, unbiased=False)
    return (x - m) / torch.sqrt(v + eps)
def _scatter_add(tgt, idx, src, axis=0):
    return tgt.clone().index_add_(axis, idx, src)
def _segment_sum(src, seg, n):
    out = torch.zeros((n,) + src.shape[1:], dtype=src.dtype)
    return out.index_add_(0, seg, src)
def _pad(x, pw):
    flat = tuple(v for pair in reversed(pw) for v in pair)
    return torch.nn.functional.pad(x, flat)

kernel_name = 'standalone__weight_only_int_squeezellm__prompt'

def setup_inputs():

    _w = (lambda a: (lambda t: t.to(torch.bfloat16) if t.is_floating_point() else t)(torch.as_tensor(a)))
    B, S, D, F = 1, 2048, 576, 4608
    bits = 8 if (2 <= 8 <= 4) else 4
    L = 2 ** bits
    qw = torch.randint(0, L, (D, F)).to(torch.int64)
    lut = (lambda *s: torch.randn(*s, dtype=torch.bfloat16) * 0.05)(L, F)
    return {
        "x": _w((lambda *s: torch.randn(*s, dtype=torch.bfloat16) * 0.05)(B, S, D)),
        "qw": _w(qw),
        "lut": _w(lut),
    }

def reference(x, qw, lut):
    w = (lambda x, i, axis: torch.take_along_dim(x, i, dim=axis))(lut, qw, axis=0)
    w = (lambda x, dt: x.to(dt))(w, x.dtype)
    return torch.einsum('bsd,df->bsf', x, w)
```

```asm
; @launch grid=(256,1,1) block=(512,1,1) lds=161792
.amdgcn_target "amdgcn-amd-amdhsa--gfx950"
.text
.globl standalone__weight_only_int_squeezellm__prompt_kernel
.p2align 8
.type standalone__weight_only_int_squeezellm__prompt_kernel,@function
standalone__weight_only_int_squeezellm__prompt_kernel:
  s_cmp_ge_u32 s2, 256
  s_cbranch_scc1 L_end
  s_load_dwordx4 s[4:7], s[0:1], 0
  s_load_dwordx4 s[8:11], s[0:1], 16
  v_lshrrev_b32 v1, 6, v0
  v_and_b32 v2, 63, v0
  v_readfirstlane_b32 s3, v1
  s_and_b32 s12, s2, 7
  s_lshr_b32 s13, s2, 3
  s_and_b32 s14, s13, 3
  s_lshl_b32 s12, s12, 2
  s_add_u32 s12, s12, s14
  s_lshr_b32 s13, s13, 2
  s_mul_i32 s14, s12, 144
  s_lshl_b32 s15, s13, 8
  v_lshrrev_b32 v3, 4, v2
  v_and_b32 v4, 15, v2
  s_and_b32 s40, s3, 3
  s_lshl_b32 s34, s40, 6
  s_add_u32 s34, s34, s15
  s_mul_i32 s41, s34, 1152
  s_mul_i32 s40, s40, 24576
  s_add_u32 s40, s40, 63488
  v_lshrrev_b32 v12, 3, v2
  s_movk_i32 s32, 1152
  v_mul_lo_u32 v12, v12, s32
  v_add_u32 v12, s41, v12
  v_and_b32 v13, 7, v2
  v_xor_b32 v13, v13, v3
  v_lshl_add_u32 v14, v13, 4, v12
  v_xor_b32 v13, 4, v13
  v_lshl_add_u32 v15, v13, 4, v12
  s_waitcnt lgkmcnt(0)
  s_mov_b32 s16, s4
  s_and_b32 s17, s5, 0xffff
  s_mov_b32 s18, 2359296
  s_mov_b32 s19, 0x00020000
  s_mov_b32 s20, s6
  s_and_b32 s21, s7, 0xffff
  s_mov_b32 s22, 10616832
  s_mov_b32 s23, 0x00020000
  s_mov_b32 s24, s8
  s_and_b32 s25, s9, 0xffff
  s_mov_b32 s26, 147456
  s_mov_b32 s27, 0x00020000
  s_mov_b32 s28, s10
  s_and_b32 s29, s11, 0xffff
  s_mov_b32 s30, 18874368
  s_mov_b32 s31, 0x00020000
  s_mov_b32 s56, 0
  s_mov_b32 s57, 8192
  s_mov_b32 s58, 16384
  s_mov_b32 s59, 24576
  s_mov_b32 s60, 36864
  s_mov_b32 s61, 45056
  s_mov_b32 s62, 53248
  s_mov_b32 s63, 61440
  s_mov_b32 s47, s3
  s_cmp_ge_u32 s3, 4
  s_cbranch_scc1 L_producer
  s_setprio 2
  v_lshrrev_b32 v5, 4, v0
  s_movk_i32 s32, 9216
  v_mul_lo_u32 v6, v5, s32
  s_lshl_b32 s33, s14, 1
  v_add_u32 v6, s33, v6
  v_and_b32 v7, 1, v4
  v_lshl_add_u32 v7, v7, 4, v6
  v_lshl_add_u32 v6, v4, 4, v6
  buffer_load_dwordx4 v[80:83], v6, s[24:27], 0 offen
  buffer_load_dwordx4 v[84:87], v7, s[24:27], 0 offen offset:256
  s_add_u32 m0, s40, 0
  s_nop 0
  buffer_load_dwordx4 v14, s[16:19], s56 offen offset:0 lds
  buffer_load_dwordx4 v15, s[16:19], s57 offen offset:1024 lds
  buffer_load_dwordx4 v14, s[16:19], s58 offen offset:2048 lds
  buffer_load_dwordx4 v15, s[16:19], s59 offen offset:3072 lds
  s_add_u32 m0, s40, 4096
  s_nop 0
  buffer_load_dwordx4 v14, s[16:19], s60 offen offset:0 lds
  buffer_load_dwordx4 v15, s[16:19], s61 offen offset:1024 lds
  buffer_load_dwordx4 v14, s[16:19], s62 offen offset:2048 lds
  buffer_load_dwordx4 v15, s[16:19], s63 offen offset:3072 lds
  v_add_u32 v14, 128, v14
  v_add_u32 v15, 128, v15
  v_lshlrev_b32 v9, 7, v5
  v_lshl_add_u32 v9, v4, 3, v9
  v_lshlrev_b32 v10, 4, v2
  v_add_u32 v10, 8192, v10
  v_xor_b32 v11, 64, v10
  v_lshrrev_b32 v12, 1, v4
  v_xor_b32 v12, v12, v3
  v_lshlrev_b32 v12, 4, v12
  v_lshl_add_u32 v12, v4, 7, v12
  v_add_u32 v12, s40, v12
  v_xor_b32 v13, 64, v12
  v_lshl_add_u32 v6, v3, 2, s34
  v_mul_lo_u32 v6, v6, s32
  v_add_u32 v6, s33, v6
  v_lshl_add_u32 v6, v4, 4, v6
  v_add_u32 v7, s34, v4
  v_mul_lo_u32 v7, v7, s32
  v_add_u32 v7, s33, v7
  v_lshl_add_u32 v7, v3, 3, v7
  s_waitcnt vmcnt(8)
  ds_write_b32 v9, v80 offset:0
  ds_write_b32 v9, v82 offset:4
  ds_write_b32 v9, v81 offset:2048
  ds_write_b32 v9, v83 offset:2052
  ds_write_b32 v9, v84 offset:4096
  ds_write_b32 v9, v86 offset:4100
  ds_write_b32 v9, v85 offset:6144
  ds_write_b32 v9, v87 offset:6148
  s_waitcnt lgkmcnt(0)
  s_barrier
  s_add_u32 m0, s40, 8192
  s_nop 0
  buffer_load_dwordx4 v14, s[16:19], s56 offen offset:0 lds
  buffer_load_dwordx4 v15, s[16:19], s57 offen offset:1024 lds
  buffer_load_dwordx4 v14, s[16:19], s58 offen offset:2048 lds
  buffer_load_dwordx4 v15, s[16:19], s59 offen offset:3072 lds
  s_add_u32 m0, s40, 12288
  s_nop 0
  buffer_load_dwordx4 v14, s[16:19], s60 offen offset:0 lds
  buffer_load_dwordx4 v15, s[16:19], s61 offen offset:1024 lds
  buffer_load_dwordx4 v14, s[16:19], s62 offen offset:2048 lds
  buffer_load_dwordx4 v15, s[16:19], s63 offen offset:3072 lds
  v_add_u32 v14, 128, v14
  v_add_u32 v15, 128, v15
  s_waitcnt vmcnt(8)
  s_barrier
  ds_read_b128 v[80:83], v10 offset:0
  ds_read_b128 v[20:23], v12 offset:0
  ds_read_b128 v[24:27], v12 offset:2048
  ds_read_b128 v[28:31], v12 offset:4096
  ds_read_b128 v[32:35], v12 offset:6144
  ds_read_b128 v[84:87], v10 offset:1024
  ds_read_b128 v[88:91], v10 offset:2048
  ds_read_b128 v[92:95], v10 offset:3072
  ds_read_b128 v[96:99], v11 offset:4096
  ds_read_b128 v[100:103], v11 offset:5120
  ds_read_b128 v[104:107], v11 offset:6144
  s_waitcnt lgkmcnt(6)
  v_mfma_f32_16x16x32_bf16 v[112:115], v[20:23], v[80:83], 0
  ds_read_b128 v[108:111], v11 offset:7168
  v_mfma_f32_16x16x32_bf16 v[116:119], v[24:27], v[80:83], 0
  v_mfma_f32_16x16x32_bf16 v[120:123], v[28:31], v[80:83], 0
  v_mfma_f32_16x16x32_bf16 v[124:127], v[32:35], v[80:83], 0
  s_add_u32 m0, s40, 16384
  s_nop 0
  buffer_load_dwordx4 v14, s[16:19], s56 offen offset:0 lds
  s_waitcnt lgkmcnt(6)
  v_mfma_f32_16x16x32_bf16 v[128:131], v[20:23], v[84:87], 0
  ds_read_b128 v[80:83], v10 offset:8192
  v_mfma_f32_16x16x32_bf16 v[132:135], v[24:27], v[84:87], 0
  v_mfma_f32_16x16x32_bf16 v[136:139], v[28:31], v[84:87], 0
  v_mfma_f32_16x16x32_bf16 v[140:143], v[32:35], v[84:87], 0
  buffer_load_dwordx4 v15, s[16:19], s57 offen offset:1024 lds
  s_waitcnt lgkmcnt(6)
  v_mfma_f32_16x16x32_bf16 v[144:147], v[20:23], v[88:91], 0
  ds_read_b128 v[84:87], v10 offset:9216
  v_mfma_f32_16x16x32_bf16 v[148:151], v[24:27], v[88:91], 0
  ds_read_b128 v[36:39], v13 offset:0
  v_mfma_f32_16x16x32_bf16 v[152:155], v[28:31], v[88:91], 0
  v_mfma_f32_16x16x32_bf16 v[156:159], v[32:35], v[88:91], 0
  s_waitcnt lgkmcnt(7)
  v_mfma_f32_16x16x32_bf16 v[160:163], v[20:23], v[92:95], 0
  ds_read_b128 v[88:91], v10 offset:10240
  v_mfma_f32_16x16x32_bf16 v[164:167], v[24:27], v[92:95], 0
  ds_read_b128 v[40:43], v13 offset:2048
  v_mfma_f32_16x16x32_bf16 v[168:171], v[28:31], v[92:95], 0
  v_mfma_f32_16x16x32_bf16 v[172:175], v[32:35], v[92:95], 0
  buffer_load_dwordx4 v14, s[16:19], s58 offen offset:2048 lds
  s_waitcnt lgkmcnt(8)
  v_mfma_f32_16x16x32_bf16 v[176:179], v[20:23], v[96:99], 0
  ds_read_b128 v[92:95], v10 offset:11264
  v_mfma_f32_16x16x32_bf16 v[180:183], v[24:27], v[96:99], 0
  ds_read_b128 v[44:47], v13 offset:4096
  v_mfma_f32_16x16x32_bf16 v[184:187], v[28:31], v[96:99], 0
  v_mfma_f32_16x16x32_bf16 v[188:191], v[32:35], v[96:99], 0
  buffer_load_dwordx4 v15, s[16:19], s59 offen offset:3072 lds
  s_waitcnt lgkmcnt(9)
  v_mfma_f32_16x16x32_bf16 v[192:195], v[20:23], v[100:103], 0
  ds_read_b128 v[96:99], v10 offset:12288
  v_mfma_f32_16x16x32_bf16 v[196:199], v[24:27], v[100:103], 0
  ds_read_b128 v[48:51], v13 offset:6144
  v_mfma_f32_16x16x32_bf16 v[200:203], v[28:31], v[100:103], 0
  v_mfma_f32_16x16x32_bf16 v[204:207], v[32:35], v[100:103], 0
  s_waitcnt lgkmcnt(10)
  v_mfma_f32_16x16x32_bf16 v[208:211], v[20:23], v[104:107], 0
  ds_read_b128 v[100:103], v11 offset:13312
  v_mfma_f32_16x16x32_bf16 v[212:215], v[24:27], v[104:107], 0
  v_mfma_f32_16x16x32_bf16 v[216:219], v[28:31], v[104:107], 0
  v_mfma_f32_16x16x32_bf16 v[220:223], v[32:35], v[104:107], 0
  s_add_u32 m0, s40, 20480
  s_nop 0
  buffer_load_dwordx4 v14, s[16:19], s60 offen offset:0 lds
  s_waitcnt lgkmcnt(10)
  v_mfma_f32_16x16x32_bf16 v[224:227], v[20:23], v[108:111], 0
  ds_read_b128 v[104:107], v11 offset:14336
  v_mfma_f32_16x16x32_bf16 v[228:231], v[24:27], v[108:111], 0
  v_mfma_f32_16x16x32_bf16 v[232:235], v[28:31], v[108:111], 0
  v_mfma_f32_16x16x32_bf16 v[236:239], v[32:35], v[108:111], 0
  buffer_load_dwordx4 v15, s[16:19], s61 offen offset:1024 lds
  s_waitcnt lgkmcnt(10)
  v_mfma_f32_16x16x32_bf16 v[240:243], v[80:83], v[20:23], 0
  ds_read_b128 v[108:111], v11 offset:15360
  v_mfma_f32_16x16x32_bf16 v[244:247], v[80:83], v[24:27], 0
  v_mfma_f32_16x16x32_bf16 v[248:251], v[80:83], v[28:31], 0
  v_mfma_f32_16x16x32_bf16 v[252:255], v[80:83], v[32:35], 0
  s_waitcnt lgkmcnt(3)
  v_mfma_f32_16x16x32_bf16 v[112:115], v[36:39], v[84:87], v[112:115]
  ds_read_b128 v[80:83], v11 offset:16384
  v_mfma_f32_16x16x32_bf16 v[116:119], v[40:43], v[84:87], v[116:119]
  v_mfma_f32_16x16x32_bf16 v[120:123], v[44:47], v[84:87], v[120:123]
  v_mfma_f32_16x16x32_bf16 v[124:127], v[48:51], v[84:87], v[124:127]
  buffer_load_dwordx4 v14, s[16:19], s62 offen offset:2048 lds
  s_waitcnt lgkmcnt(4)
  v_mfma_f32_16x16x32_bf16 v[128:131], v[36:39], v[88:91], v[128:131]
  ds_read_b128 v[84:87], v10 offset:17408
  v_mfma_f32_16x16x32_bf16 v[132:135], v[40:43], v[88:91], v[132:135]
  v_mfma_f32_16x16x32_bf16 v[136:139], v[44:47], v[88:91], v[136:139]
  v_mfma_f32_16x16x32_bf16 v[140:143], v[48:51], v[88:91], v[140:143]
  buffer_load_dwordx4 v15, s[16:19], s63 offen offset:3072 lds
  v_add_u32 v14, 128, v14
  v_add_u32 v15, 128, v15
  s_waitcnt lgkmcnt(5)
  v_mfma_f32_16x16x32_bf16 v[144:147], v[36:39], v[92:95], v[144:147]
  s_waitcnt vmcnt(8)
  s_barrier
  ds_read_b128 v[88:91], v10 offset:18432
  v_mfma_f32_16x16x32_bf16 v[148:151], v[40:43], v[92:95], v[148:151]
  ds_read_b128 v[52:55], v12 offset:8192
  v_mfma_f32_16x16x32_bf16 v[152:155], v[44:47], v[92:95], v[152:155]
  v_mfma_f32_16x16x32_bf16 v[156:159], v[48:51], v[92:95], v[156:159]
  s_waitcnt lgkmcnt(7)
  v_mfma_f32_16x16x32_bf16 v[160:163], v[36:39], v[96:99], v[160:163]
  ds_read_b128 v[92:95], v10 offset:19456
  v_mfma_f32_16x16x32_bf16 v[164:167], v[40:43], v[96:99], v[164:167]
  ds_read_b128 v[56:59], v12 offset:10240
  v_mfma_f32_16x16x32_bf16 v[168:171], v[44:47], v[96:99], v[168:171]
  v_mfma_f32_16x16x32_bf16 v[172:175], v[48:51], v[96:99], v[172:175]
  s_waitcnt lgkmcnt(8)
  v_mfma_f32_16x16x32_bf16 v[176:179], v[36:39], v[100:103], v[176:179]
  ds_read_b128 v[96:99], v10 offset:20480
  v_mfma_f32_16x16x32_bf16 v[180:183], v[40:43], v[100:103], v[180:183]
  ds_read_b128 v[60:63], v12 offset:12288
  v_mfma_f32_16x16x32_bf16 v[184:187], v[44:47], v[100:103], v[184:187]
  v_mfma_f32_16x16x32_bf16 v[188:191], v[48:51], v[100:103], v[188:191]
  s_waitcnt lgkmcnt(9)
  v_mfma_f32_16x16x32_bf16 v[192:195], v[36:39], v[104:107], v[192:195]
  ds_read_b128 v[100:103], v10 offset:21504
  v_mfma_f32_16x16x32_bf16 v[196:199], v[40:43], v[104:107], v[196:199]
  ds_read_b128 v[64:67], v12 offset:14336
  v_mfma_f32_16x16x32_bf16 v[200:203], v[44:47], v[104:107], v[200:203]
  v_mfma_f32_16x16x32_bf16 v[204:207], v[48:51], v[104:107], v[204:207]
  s_waitcnt lgkmcnt(10)
  v_mfma_f32_16x16x32_bf16 v[208:211], v[36:39], v[108:111], v[208:211]
  ds_read_b128 v[104:107], v11 offset:22528
  v_mfma_f32_16x16x32_bf16 v[212:215], v[40:43], v[108:111], v[212:215]
  v_mfma_f32_16x16x32_bf16 v[216:219], v[44:47], v[108:111], v[216:219]
  v_mfma_f32_16x16x32_bf16 v[220:223], v[48:51], v[108:111], v[220:223]
  s_waitcnt lgkmcnt(10)
  v_mfma_f32_16x16x32_bf16 v[224:227], v[36:39], v[80:83], v[224:227]
  ds_read_b128 v[108:111], v11 offset:23552
  v_mfma_f32_16x16x32_bf16 v[228:231], v[40:43], v[80:83], v[228:231]
  v_mfma_f32_16x16x32_bf16 v[232:235], v[44:47], v[80:83], v[232:235]
  v_mfma_f32_16x16x32_bf16 v[236:239], v[48:51], v[80:83], v[236:239]
  s_waitcnt lgkmcnt(10)
  v_mfma_f32_16x16x32_bf16 v[240:243], v[84:87], v[36:39], v[240:243]
  ds_read_b128 v[80:83], v11 offset:24576
  v_mfma_f32_16x16x32_bf16 v[244:247], v[84:87], v[40:43], v[244:247]
  v_mfma_f32_16x16x32_bf16 v[248:251], v[84:87], v[44:47], v[248:251]
  v_mfma_f32_16x16x32_bf16 v[252:255], v[84:87], v[48:51], v[252:255]
  s_waitcnt lgkmcnt(3)
  v_mfma_f32_16x16x32_bf16 v[112:115], v[52:55], v[88:91], v[112:115]
  ds_read_b128 v[84:87], v11 offset:25600
  v_mfma_f32_16x16x32_bf16 v[116:119], v[56:59], v[88:91], v[116:119]
  v_mfma_f32_16x16x32_bf16 v[120:123], v[60:63], v[88:91], v[120:123]
  v_mfma_f32_16x16x32_bf16 v[124:127], v[64:67], v[88:91], v[124:127]
  s_add_u32 m0, s40, 0
  s_nop 0
  buffer_load_dwordx4 v14, s[16:19], s56 offen offset:0 lds
  s_waitcnt lgkmcnt(4)
  v_mfma_f32_16x16x32_bf16 v[128:131], v[52:55], v[92:95], v[128:131]
  ds_read_b128 v[88:91], v10 offset:26624
  v_mfma_f32_16x16x32_bf16 v[132:135], v[56:59], v[92:95], v[132:135]
  v_mfma_f32_16x16x32_bf16 v[136:139], v[60:63], v[92:95], v[136:139]
  v_mfma_f32_16x16x32_bf16 v[140:143], v[64:67], v[92:95], v[140:143]
  buffer_load_dwordx4 v15, s[16:19], s57 offen offset:1024 lds
  s_waitcnt lgkmcnt(5)
  v_mfma_f32_16x16x32_bf16 v[144:147], v[52:55], v[96:99], v[144:147]
  ds_read_b128 v[92:95], v10 offset:27648
  v_mfma_f32_16x16x32_bf16 v[148:151], v[56:59], v[96:99], v[148:151]
  ds_read_b128 v[20:23], v13 offset:8192
  v_mfma_f32_16x16x32_bf16 v[152:155], v[60:63], v[96:99], v[152:155]
  v_mfma_f32_16x16x32_bf16 v[156:159], v[64:67], v[96:99], v[156:159]
  s_waitcnt lgkmcnt(7)
  v_mfma_f32_16x16x32_bf16 v[160:163], v[52:55], v[100:103], v[160:163]
  ds_read_b128 v[96:99], v10 offset:28672
  v_mfma_f32_16x16x32_bf16 v[164:167], v[56:59], v[100:103], v[164:167]
  ds_read_b128 v[24:27], v13 offset:10240
  v_mfma_f32_16x16x32_bf16 v[168:171], v[60:63], v[100:103], v[168:171]
  v_mfma_f32_16x16x32_bf16 v[172:175], v[64:67], v[100:103], v[172:175]
  buffer_load_dwordx4 v14, s[16:19], s58 offen offset:2048 lds
  s_waitcnt lgkmcnt(8)
  v_mfma_f32_16x16x32_bf16 v[176:179], v[52:55], v[104:107], v[176:179]
  ds_read_b128 v[100:103], v10 offset:29696
  v_mfma_f32_16x16x32_bf16 v[180:183], v[56:59], v[104:107], v[180:183]
  ds_read_b128 v[28:31], v13 offset:12288
  v_mfma_f32_16x16x32_bf16 v[184:187], v[60:63], v[104:107], v[184:187]
  v_mfma_f32_16x16x32_bf16 v[188:191], v[64:67], v[104:107], v[188:191]
  buffer_load_dwordx4 v15, s[16:19], s59 offen offset:3072 lds
  s_waitcnt lgkmcnt(9)
  v_mfma_f32_16x16x32_bf16 v[192:195], v[52:55], v[108:111], v[192:195]
  ds_read_b128 v[104:107], v10 offset:30720
  v_mfma_f32_16x16x32_bf16 v[196:199], v[56:59], v[108:111], v[196:199]
  ds_read_b128 v[32:35], v13 offset:14336
  v_mfma_f32_16x16x32_bf16 v[200:203], v[60:63], v[108:111], v[200:203]
  v_mfma_f32_16x16x32_bf16 v[204:207], v[64:67], v[108:111], v[204:207]
  s_waitcnt lgkmcnt(10)
  v_mfma_f32_16x16x32_bf16 v[208:211], v[52:55], v[80:83], v[208:211]
  ds_read_b128 v[108:111], v11 offset:31744
  v_mfma_f32_16x16x32_bf16 v[212:215], v[56:59], v[80:83], v[212:215]
  v_mfma_f32_16x16x32_bf16 v[216:219], v[60:63], v[80:83], v[216:219]
  v_mfma_f32_16x16x32_bf16 v[220:223], v[64:67], v[80:83], v[220:223]
  s_add_u32 m0, s40, 4096
  s_nop 0
  buffer_load_dwordx4 v14, s[16:19], s60 offen offset:0 lds
  s_waitcnt lgkmcnt(10)
  v_mfma_f32_16x16x32_bf16 v[224:227], v[52:55], v[84:87], v[224:227]
  ds_read_b128 v[80:83], v11 offset:32768
  v_mfma_f32_16x16x32_bf16 v[228:231], v[56:59], v[84:87], v[228:231]
  v_mfma_f32_16x16x32_bf16 v[232:235], v[60:63], v[84:87], v[232:235]
  v_mfma_f32_16x16x32_bf16 v[236:239], v[64:67], v[84:87], v[236:239]
  buffer_load_dwordx4 v15, s[16:19], s61 offen offset:1024 lds
  s_waitcnt lgkmcnt(10)
  v_mfma_f32_16x16x32_bf16 v[240:243], v[88:91], v[52:55], v[240:243]
  ds_read_b128 v[84:87], v11 offset:33792
  v_mfma_f32_16x16x32_bf16 v[244:247], v[88:91], v[56:59], v[244:247]
  v_mfma_f32_16x16x32_bf16 v[248:251], v[88:91], v[60:63], v[248:251]
  v_mfma_f32_16x16x32_bf16 v[252:255], v[88:91], v[64:67], v[252:255]
  s_waitcnt lgkmcnt(3)
  v_mfma_f32_16x16x32_bf16 v[112:115], v[20:23], v[92:95], v[112:115]
  ds_read_b128 v[88:91], v11 offset:34816
  v_mfma_f32_16x16x32_bf16 v[116:119], v[24:27], v[92:95], v[116:119]
  v_mfma_f32_16x16x32_bf16 v[120:123], v[28:31], v[92:95], v[120:123]
  v_mfma_f32_16x16x32_bf16 v[124:127], v[32:35], v[92:95], v[124:127]
  buffer_load_dwordx4 v14, s[16:19], s62 offen offset:2048 lds
  s_waitcnt lgkmcnt(4)
  v_mfma_f32_16x16x32_bf16 v[128:131], v[20:23], v[96:99], v[128:131]
  ds_read_b128 v[92:95], v10 offset:35840
  v_mfma_f32_16x16x32_bf16 v[132:135], v[24:27], v[96:99], v[132:135]
  v_mfma_f32_16x16x32_bf16 v[136:139], v[28:31], v[96:99], v[136:139]
  v_mfma_f32_16x16x32_bf16 v[140:143], v[32:35], v[96:99], v[140:143]
  buffer_load_dwordx4 v15, s[16:19], s63 offen offset:3072 lds
  v_add_u32 v14, 128, v14
  v_add_u32 v15, 128, v15
  s_waitcnt lgkmcnt(5)
  v_mfma_f32_16x16x32_bf16 v[144:147], v[20:23], v[100:103], v[144:147]
  s_waitcnt vmcnt(8)
  s_barrier
  ds_read_b128 v[96:99], v10 offset:36864
  v_mfma_f32_16x16x32_bf16 v[148:151], v[24:27], v[100:103], v[148:151]
  ds_read_b128 v[36:39], v12 offset:16384
  v_mfma_f32_16x16x32_bf16 v[152:155], v[28:31], v[100:103], v[152:155]
  v_mfma_f32_16x16x32_bf16 v[156:159], v[32:35], v[100:103], v[156:159]
  s_waitcnt lgkmcnt(7)
  v_mfma_f32_16x16x32_bf16 v[160:163], v[20:23], v[104:107], v[160:163]
  ds_read_b128 v[100:103], v10 offset:37888
  v_mfma_f32_16x16x32_bf16 v[164:167], v[24:27], v[104:107], v[164:167]
  ds_read_b128 v[40:43], v12 offset:18432
  v_mfma_f32_16x16x32_bf16 v[168:171], v[28:31], v[104:107], v[168:171]
  v_mfma_f32_16x16x32_bf16 v[172:175], v[32:35], v[104:107], v[172:175]
  s_waitcnt lgkmcnt(8)
  v_mfma_f32_16x16x32_bf16 v[176:179], v[20:23], v[108:111], v[176:179]
  ds_read_b128 v[104:107], v10 offset:38912
  v_mfma_f32_16x16x32_bf16 v[180:183], v[24:27], v[108:111], v[180:183]
  ds_read_b128 v[44:47], v12 offset:20480
  v_mfma_f32_16x16x32_bf16 v[184:187], v[28:31], v[108:111], v[184:187]
  v_mfma_f32_16x16x32_bf16 v[188:191], v[32:35], v[108:111], v[188:191]
  s_waitcnt lgkmcnt(9)
  v_mfma_f32_16x16x32_bf16 v[192:195], v[20:23], v[80:83], v[192:195]
  ds_read_b128 v[108:111], v10 offset:39936
  v_mfma_f32_16x16x32_bf16 v[196:199], v[24:27], v[80:83], v[196:199]
  ds_read_b128 v[48:51], v12 offset:22528
  v_mfma_f32_16x16x32_bf16 v[200:203], v[28:31], v[80:83], v[200:203]
  v_mfma_f32_16x16x32_bf16 v[204:207], v[32:35], v[80:83], v[204:207]
  s_waitcnt lgkmcnt(10)
  v_mfma_f32_16x16x32_bf16 v[208:211], v[20:23], v[84:87], v[208:211]
  ds_read_b128 v[80:83], v11 offset:40960
  v_mfma_f32_16x16x32_bf16 v[212:215], v[24:27], v[84:87], v[212:215]
  v_mfma_f32_16x16x32_bf16 v[216:219], v[28:31], v[84:87], v[216:219]
  v_mfma_f32_16x16x32_bf16 v[220:223], v[32:35], v[84:87], v[220:223]
  s_waitcnt lgkmcnt(10)
  v_mfma_f32_16x16x32_bf16 v[224:227], v[20:23], v[88:91], v[224:227]
  ds_read_b128 v[84:87], v11 offset:41984
  v_mfma_f32_16x16x32_bf16 v[228:231], v[24:27], v[88:91], v[228:231]
  v_mfma_f32_16x16x32_bf16 v[232:235], v[28:31], v[88:91], v[232:235]
  v_mfma_f32_16x16x32_bf16 v[236:239], v[32:35], v[88:91], v[236:239]
  s_waitcnt lgkmcnt(10)
  v_mfma_f32_16x16x32_bf16 v[240:243], v[92:95], v[20:23], v[240:243]
  ds_read_b128 v[88:91], v11 offset:43008
  v_mfma_f32_16x16x32_bf16 v[244:247], v[92:95], v[24:27], v[244:247]
  v_mfma_f32_16x16x32_bf16 v[248:251], v[92:95], v[28:31], v[248:251]
  v_mfma_f32_16x16x32_bf16 v[252:255], v[92:95], v[32:35], v[252:255]
  s_waitcnt lgkmcnt(3)
  v_mfma_f32_16x16x32_bf16 v[112:115], v[36:39], v[96:99], v[112:115]
  ds_read_b128 v[92:95], v11 offset:44032
  v_mfma_f32_16x16x32_bf16 v[116:119], v[40:43], v[96:99], v[116:119]
  v_mfma_f32_16x16x32_bf16 v[120:123], v[44:47], v[96:99], v[120:123]
  v_mfma_f32_16x16x32_bf16 v[124:127], v[48:51], v[96:99], v[124:127]
  s_add_u32 m0, s40, 8192
  s_nop 0
  buffer_load_dwordx4 v14, s[16:19], s56 offen offset:0 lds
  s_waitcnt lgkmcnt(4)
  v_mfma_f32_16x16x32_bf16 v[128:131], v[36:39], v[100:103], v[128:131]
  ds_read_b128 v[96:99], v10 offset:45056
  v_mfma_f32_16x16x32_bf16 v[132:135], v[40:43], v[100:103], v[132:135]
  v_mfma_f32_16x16x32_bf16 v[136:139], v[44:47], v[100:103], v[136:139]
  v_mfma_f32_16x16x32_bf16 v[140:143], v[48:51], v[100:103], v[140:143]
  buffer_load_dwordx4 v15, s[16:19], s57 offen offset:1024 lds
  s_waitcnt lgkmcnt(5)
  v_mfma_f32_16x16x32_bf16 v[144:147], v[36:39], v[104:107], v[144:147]
  ds_read_b128 v[100:103], v10 offset:46080
  v_mfma_f32_16x16x32_bf16 v[148:151], v[40:43], v[104:107], v[148:151]
  ds_read_b128 v[52:55], v13 offset:16384
  v_mfma_f32_16x16x32_bf16 v[152:155], v[44:47], v[104:107], v[152:155]
  v_mfma_f32_16x16x32_bf16 v[156:159], v[48:51], v[104:107], v[156:159]
  s_waitcnt lgkmcnt(7)
  v_mfma_f32_16x16x32_bf16 v[160:163], v[36:39], v[108:111], v[160:163]
  ds_read_b128 v[104:107], v10 offset:47104
  v_mfma_f32_16x16x32_bf16 v[164:167], v[40:43], v[108:111], v[164:167]
  ds_read_b128 v[56:59], v13 offset:18432
  v_mfma_f32_16x16x32_bf16 v[168:171], v[44:47], v[108:111], v[168:171]
  v_mfma_f32_16x16x32_bf16 v[172:175], v[48:51], v[108:111], v[172:175]
  buffer_load_dwordx4 v14, s[16:19], s58 offen offset:2048 lds
  s_waitcnt lgkmcnt(8)
  v_mfma_f32_16x16x32_bf16 v[176:179], v[36:39], v[80:83], v[176:179]
  ds_read_b128 v[108:111], v10 offset:48128
  v_mfma_f32_16x16x32_bf16 v[180:183], v[40:43], v[80:83], v[180:183]
  ds_read_b128 v[60:63], v13 offset:20480
  v_mfma_f32_16x16x32_bf16 v[184:187], v[44:47], v[80:83], v[184:187]
  v_mfma_f32_16x16x32_bf16 v[188:191], v[48:51], v[80:83], v[188:191]
  buffer_load_dwordx4 v15, s[16:19], s59 offen offset:3072 lds
  s_waitcnt lgkmcnt(9)
  v_mfma_f32_16x16x32_bf16 v[192:195], v[36:39], v[84:87], v[192:195]
  ds_read_b128 v[80:83], v10 offset:49152
  v_mfma_f32_16x16x32_bf16 v[196:199], v[40:43], v[84:87], v[196:199]
  ds_read_b128 v[64:67], v13 offset:22528
  v_mfma_f32_16x16x32_bf16 v[200:203], v[44:47], v[84:87], v[200:203]
  v_mfma_f32_16x16x32_bf16 v[204:207], v[48:51], v[84:87], v[204:207]
  s_waitcnt lgkmcnt(10)
  v_mfma_f32_16x16x32_bf16 v[208:211], v[36:39], v[88:91], v[208:211]
  ds_read_b128 v[84:87], v11 offset:50176
  v_mfma_f32_16x16x32_bf16 v[212:215], v[40:43], v[88:91], v[212:215]
  v_mfma_f32_16x16x32_bf16 v[216:219], v[44:47], v[88:91], v[216:219]
  v_mfma_f32_16x16x32_bf16 v[220:223], v[48:51], v[88:91], v[220:223]
  s_add_u32 m0, s40, 12288
  s_nop 0
  buffer_load_dwordx4 v14, s[16:19], s60 offen offset:0 lds
  s_waitcnt lgkmcnt(10)
  v_mfma_f32_16x16x32_bf16 v[224:227], v[36:39], v[92:95], v[224:227]
  ds_read_b128 v[88:91], v11 offset:51200
  v_mfma_f32_16x16x32_bf16 v[228:231], v[40:43], v[92:95], v[228:231]
  v_mfma_f32_16x16x32_bf16 v[232:235], v[44:47], v[92:95], v[232:235]
  v_mfma_f32_16x16x32_bf16 v[236:239], v[48:51], v[92:95], v[236:239]
  buffer_load_dwordx4 v15, s[16:19], s61 offen offset:1024 lds
  s_waitcnt lgkmcnt(10)
  v_mfma_f32_16x16x32_bf16 v[240:243], v[96:99], v[36:39], v[240:243]
  ds_read_b128 v[92:95], v11 offset:52224
  v_mfma_f32_16x16x32_bf16 v[244:247], v[96:99], v[40:43], v[244:247]
  v_mfma_f32_16x16x32_bf16 v[248:251], v[96:99], v[44:47], v[248:251]
  v_mfma_f32_16x16x32_bf16 v[252:255], v[96:99], v[48:51], v[252:255]
  s_waitcnt lgkmcnt(3)
  v_mfma_f32_16x16x32_bf16 v[112:115], v[52:55], v[100:103], v[112:115]
  ds_read_b128 v[96:99], v11 offset:53248
  v_mfma_f32_16x16x32_bf16 v[116:119], v[56:59], v[100:103], v[116:119]
  v_mfma_f32_16x16x32_bf16 v[120:123], v[60:63], v[100:103], v[120:123]
  v_mfma_f32_16x16x32_bf16 v[124:127], v[64:67], v[100:103], v[124:127]
  buffer_load_dwordx4 v14, s[16:19], s62 offen offset:2048 lds
  s_waitcnt lgkmcnt(4)
  v_mfma_f32_16x16x32_bf16 v[128:131], v[52:55], v[104:107], v[128:131]
  ds_read_b128 v[100:103], v10 offset:54272
  v_mfma_f32_16x16x32_bf16 v[132:135], v[56:59], v[104:107], v[132:135]
  v_mfma_f32_16x16x32_bf16 v[136:139], v[60:63], v[104:107], v[136:139]
  v_mfma_f32_16x16x32_bf16 v[140:143], v[64:67], v[104:107], v[140:143]
  buffer_load_dwordx4 v15, s[16:19], s63 offen offset:3072 lds
  v_add_u32 v14, 128, v14
  v_add_u32 v15, 128, v15
  s_waitcnt lgkmcnt(5)
  v_mfma_f32_16x16x32_bf16 v[144:147], v[52:55], v[108:111], v[144:147]
  s_waitcnt vmcnt(8)
  s_barrier
  ds_read_b128 v[104:107], v10 offset:0
  v_mfma_f32_16x16x32_bf16 v[148:151], v[56:59], v[108:111], v[148:151]
  ds_read_b128 v[20:23], v12 offset:0
  v_mfma_f32_16x16x32_bf16 v[152:155], v[60:63], v[108:111], v[152:155]
  v_mfma_f32_16x16x32_bf16 v[156:159], v[64:67], v[108:111], v[156:159]
  s_waitcnt lgkmcnt(7)
  v_mfma_f32_16x16x32_bf16 v[160:163], v[52:55], v[80:83], v[160:163]
  ds_read_b128 v[108:111], v10 offset:1024
  v_mfma_f32_16x16x32_bf16 v[164:167], v[56:59], v[80:83], v[164:167]
  ds_read_b128 v[24:27], v12 offset:2048
  v_mfma_f32_16x16x32_bf16 v[168:171], v[60:63], v[80:83], v[168:171]
  v_mfma_f32_16x16x32_bf16 v[172:175], v[64:67], v[80:83], v[172:175]
  s_waitcnt lgkmcnt(8)
  v_mfma_f32_16x16x32_bf16 v[176:179], v[52:55], v[84:87], v[176:179]
  ds_read_b128 v[80:83], v10 offset:2048
  v_mfma_f32_16x16x32_bf16 v[180:183], v[56:59], v[84:87], v[180:183]
  ds_read_b128 v[28:31], v12 offset:4096
  v_mfma_f32_16x16x32_bf16 v[184:187], v[60:63], v[84:87], v[184:187]
  v_mfma_f32_16x16x32_bf16 v[188:191], v[64:67], v[84:87], v[188:191]
  s_waitcnt lgkmcnt(9)
  v_mfma_f32_16x16x32_bf16 v[192:195], v[52:55], v[88:91], v[192:195]
  ds_read_b128 v[84:87], v10 offset:3072
  v_mfma_f32_16x16x32_bf16 v[196:199], v[56:59], v[88:91], v[196:199]
  ds_read_b128 v[32:35], v12 offset:6144
  v_mfma_f32_16x16x32_bf16 v[200:203], v[60:63], v[88:91], v[200:203]
  v_mfma_f32_16x16x32_bf16 v[204:207], v[64:67], v[88:91], v[204:207]
  s_waitcnt lgkmcnt(10)
  v_mfma_f32_16x16x32_bf16 v[208:211], v[52:55], v[92:95], v[208:211]
  ds_read_b128 v[88:91], v11 offset:4096
  v_mfma_f32_16x16x32_bf16 v[212:215], v[56:59], v[92:95], v[212:215]
  v_mfma_f32_16x16x32_bf16 v[216:219], v[60:63], v[92:95], v[216:219]
  v_mfma_f32_16x16x32_bf16 v[220:223], v[64:67], v[92:95], v[220:223]
  s_waitcnt lgkmcnt(10)
  v_mfma_f32_16x16x32_bf16 v[224:227], v[52:55], v[96:99], v[224:227]
  ds_read_b128 v[92:95], v11 offset:5120
  v_mfma_f32_16x16x32_bf16 v[228:231], v[56:59], v[96:99], v[228:231]
  v_mfma_f32_16x16x32_bf16 v[232:235], v[60:63], v[96:99], v[232:235]
  v_mfma_f32_16x16x32_bf16 v[236:239], v[64:67], v[96:99], v[236:239]
  s_waitcnt lgkmcnt(10)
  v_mfma_f32_16x16x32_bf16 v[240:243], v[100:103], v[52:55], v[240:243]
  ds_read_b128 v[96:99], v11 offset:6144
  v_mfma_f32_16x16x32_bf16 v[244:247], v[100:103], v[56:59], v[244:247]
  v_mfma_f32_16x16x32_bf16 v[248:251], v[100:103], v[60:63], v[248:251]
  v_mfma_f32_16x16x32_bf16 v[252:255], v[100:103], v[64:67], v[252:255]
  s_waitcnt lgkmcnt(3)
  v_mfma_f32_16x16x32_bf16 v[112:115], v[20:23], v[104:107], v[112:115]
  ds_read_b128 v[100:103], v11 offset:7168
  v_mfma_f32_16x16x32_bf16 v[116:119], v[24:27], v[104:107], v[116:119]
  v_mfma_f32_16x16x32_bf16 v[120:123], v[28:31], v[104:107], v[120:123]
  v_mfma_f32_16x16x32_bf16 v[124:127], v[32:35], v[104:107], v[124:127]
  s_add_u32 m0, s40, 16384
  s_nop 0
  buffer_load_dwordx4 v14, s[16:19], s56 offen offset:0 lds
  s_waitcnt lgkmcnt(4)
  v_mfma_f32_16x16x32_bf16 v[128:131], v[20:23], v[108:111], v[128:131]
  ds_read_b128 v[104:107], v10 offset:8192
  v_mfma_f32_16x16x32_bf16 v[132:135], v[24:27], v[108:111], v[132:135]
  v_mfma_f32_16x16x32_bf16 v[136:139], v[28:31], v[108:111], v[136:139]
  v_mfma_f32_16x16x32_bf16 v[140:143], v[32:35], v[108:111], v[140:143]
  buffer_load_dwordx4 v15, s[16:19], s57 offen offset:1024 lds
  s_waitcnt lgkmcnt(5)
  v_mfma_f32_16x16x32_bf16 v[144:147], v[20:23], v[80:83], v[144:147]
  ds_read_b128 v[108:111], v10 offset:9216
  v_mfma_f32_16x16x32_bf16 v[148:151], v[24:27], v[80:83], v[148:151]
  ds_read_b128 v[36:39], v13 offset:0
  v_mfma_f32_16x16x32_bf16 v[152:155], v[28:31], v[80:83], v[152:155]
  v_mfma_f32_16x16x32_bf16 v[156:159], v[32:35], v[80:83], v[156:159]
  s_waitcnt lgkmcnt(7)
  v_mfma_f32_16x16x32_bf16 v[160:163], v[20:23], v[84:87], v[160:163]
  ds_read_b128 v[80:83], v10 offset:10240
  v_mfma_f32_16x16x32_bf16 v[164:167], v[24:27], v[84:87], v[164:167]
  ds_read_b128 v[40:43], v13 offset:2048
  v_mfma_f32_16x16x32_bf16 v[168:171], v[28:31], v[84:87], v[168:171]
  v_mfma_f32_16x16x32_bf16 v[172:175], v[32:35], v[84:87], v[172:175]
  buffer_load_dwordx4 v14, s[16:19], s58 offen offset:2048 lds
  s_waitcnt lgkmcnt(8)
  v_mfma_f32_16x16x32_bf16 v[176:179], v[20:23], v[88:91], v[176:179]
  ds_read_b128 v[84:87], v10 offset:11264
  v_mfma_f32_16x16x32_bf16 v[180:183], v[24:27], v[88:91], v[180:183]
  ds_read_b128 v[44:47], v13 offset:4096
  v_mfma_f32_16x16x32_bf16 v[184:187], v[28:31], v[88:91], v[184:187]
  v_mfma_f32_16x16x32_bf16 v[188:191], v[32:35], v[88:91], v[188:191]
  buffer_load_dwordx4 v15, s[16:19], s59 offen offset:3072 lds
  s_waitcnt lgkmcnt(9)
  v_mfma_f32_16x16x32_bf16 v[192:195], v[20:23], v[92:95], v[192:195]
  ds_read_b128 v[88:91], v10 offset:12288
  v_mfma_f32_16x16x32_bf16 v[196:199], v[24:27], v[92:95], v[196:199]
  ds_read_b128 v[48:51], v13 offset:6144
  v_mfma_f32_16x16x32_bf16 v[200:203], v[28:31], v[92:95], v[200:203]
  v_mfma_f32_16x16x32_bf16 v[204:207], v[32:35], v[92:95], v[204:207]
  s_waitcnt lgkmcnt(10)
  v_mfma_f32_16x16x32_bf16 v[208:211], v[20:23], v[96:99], v[208:211]
  ds_read_b128 v[92:95], v11 offset:13312
  v_mfma_f32_16x16x32_bf16 v[212:215], v[24:27], v[96:99], v[212:215]
  v_mfma_f32_16x16x32_bf16 v[216:219], v[28:31], v[96:99], v[216:219]
  v_mfma_f32_16x16x32_bf16 v[220:223], v[32:35], v[96:99], v[220:223]
  s_add_u32 m0, s40, 20480
  s_nop 0
  buffer_load_dwordx4 v14, s[16:19], s60 offen offset:0 lds
  s_waitcnt lgkmcnt(10)
  v_mfma_f32_16x16x32_bf16 v[224:227], v[20:23], v[100:103], v[224:227]
  ds_read_b128 v[96:99], v11 offset:14336
  v_mfma_f32_16x16x32_bf16 v[228:231], v[24:27], v[100:103], v[228:231]
  v_mfma_f32_16x16x32_bf16 v[232:235], v[28:31], v[100:103], v[232:235]
  v_mfma_f32_16x16x32_bf16 v[236:239], v[32:35], v[100:103], v[236:239]
  buffer_load_dwordx4 v15, s[16:19], s61 offen offset:1024 lds
  s_waitcnt lgkmcnt(10)
  v_mfma_f32_16x16x32_bf16 v[240:243], v[104:107], v[20:23], v[240:243]
  ds_read_b128 v[100:103], v11 offset:15360
  v_mfma_f32_16x16x32_bf16 v[244:247], v[104:107], v[24:27], v[244:247]
  v_mfma_f32_16x16x32_bf16 v[248:251], v[104:107], v[28:31], v[248:251]
  v_mfma_f32_16x16x32_bf16 v[252:255], v[104:107], v[32:35], v[252:255]
  s_waitcnt lgkmcnt(3)
  v_mfma_f32_16x16x32_bf16 v[112:115], v[36:39], v[108:111], v[112:115]
  ds_read_b128 v[104:107], v11 offset:16384
  v_mfma_f32_16x16x32_bf16 v[116:119], v[40:43], v[108:111], v[116:119]
  v_mfma_f32_16x16x32_bf16 v[120:123], v[44:47], v[108:111], v[120:123]
  v_mfma_f32_16x16x32_bf16 v[124:127], v[48:51], v[108:111], v[124:127]
  buffer_load_dwordx4 v14, s[16:19], s62 offen offset:2048 lds
  s_waitcnt lgkmcnt(4)
  v_mfma_f32_16x16x32_bf16 v[128:131], v[36:39], v[80:83], v[128:131]
  ds_read_b128 v[108:111], v10 offset:17408
  v_mfma_f32_16x16x32_bf16 v[132:135], v[40:43], v[80:83], v[132:135]
  v_mfma_f32_16x16x32_bf16 v[136:139], v[44:47], v[80:83], v[136:139]
  v_mfma_f32_16x16x32_bf16 v[140:143], v[48:51], v[80:83], v[140:143]
  buffer_load_dwordx4 v15, s[16:19], s63 offen offset:3072 lds
  v_add_u32 v14, 128, v14
  v_add_u32 v15, 128, v15
  s_waitcnt lgkmcnt(5)
  v_mfma_f32_16x16x32_bf16 v[144:147], v[36:39], v[84:87], v[144:147]
  s_waitcnt vmcnt(8)
  s_barrier
  ds_read_b128 v[80:83], v10 offset:18432
  v_mfma_f32_16x16x32_bf16 v[148:151], v[40:43], v[84:87], v[148:151]
  ds_read_b128 v[52:55], v12 offset:8192
  v_mfma_f32_16x16x32_bf16 v[152:155], v[44:47], v[84:87], v[152:155]
  v_mfma_f32_16x16x32_bf16 v[156:159], v[48:51], v[84:87], v[156:159]
  s_waitcnt lgkmcnt(7)
  v_mfma_f32_16x16x32_bf16 v[160:163], v[36:39], v[88:91], v[160:163]
  ds_read_b128 v[84:87], v10 offset:19456
  v_mfma_f32_16x16x32_bf16 v[164:167], v[40:43], v[88:91], v[164:167]
  ds_read_b128 v[56:59], v12 offset:10240
  v_mfma_f32_16x16x32_bf16 v[168:171], v[44:47], v[88:91], v[168:171]
  v_mfma_f32_16x16x32_bf16 v[172:175], v[48:51], v[88:91], v[172:175]
  s_waitcnt lgkmcnt(8)
  v_mfma_f32_16x16x32_bf16 v[176:179], v[36:39], v[92:95], v[176:179]
  ds_read_b128 v[88:91], v10 offset:20480
  v_mfma_f32_16x16x32_bf16 v[180:183], v[40:43], v[92:95], v[180:183]
  ds_read_b128 v[60:63], v12 offset:12288
  v_mfma_f32_16x16x32_bf16 v[184:187], v[44:47], v[92:95], v[184:187]
  v_mfma_f32_16x16x32_bf16 v[188:191], v[48:51], v[92:95], v[188:191]
  s_waitcnt lgkmcnt(9)
  v_mfma_f32_16x16x32_bf16 v[192:195], v[36:39], v[96:99], v[192:195]
  ds_read_b128 v[92:95], v10 offset:21504
  v_mfma_f32_16x16x32_bf16 v[196:199], v[40:43], v[96:99], v[196:199]
  ds_read_b128 v[64:67], v12 offset:14336
  v_mfma_f32_16x16x32_bf16 v[200:203], v[44:47], v[96:99], v[200:203]
  v_mfma_f32_16x16x32_bf16 v[204:207], v[48:51], v[96:99], v[204:207]
  s_waitcnt lgkmcnt(10)
  v_mfma_f32_16x16x32_bf16 v[208:211], v[36:39], v[100:103], v[208:211]
  ds_read_b128 v[96:99], v11 offset:22528
  v_mfma_f32_16x16x32_bf16 v[212:215], v[40:43], v[100:103], v[212:215]
  v_mfma_f32_16x16x32_bf16 v[216:219], v[44:47], v[100:103], v[216:219]
  v_mfma_f32_16x16x32_bf16 v[220:223], v[48:51], v[100:103], v[220:223]
  s_waitcnt lgkmcnt(10)
  v_mfma_f32_16x16x32_bf16 v[224:227], v[36:39], v[104:107], v[224:227]
  ds_read_b128 v[100:103], v11 offset:23552
  v_mfma_f32_16x16x32_bf16 v[228:231], v[40:43], v[104:107], v[228:231]
  v_mfma_f32_16x16x32_bf16 v[232:235], v[44:47], v[104:107], v[232:235]
  v_mfma_f32_16x16x32_bf16 v[236:239], v[48:51], v[104:107], v[236:239]
  s_waitcnt lgkmcnt(10)
  v_mfma_f32_16x16x32_bf16 v[240:243], v[108:111], v[36:39], v[240:243]
  ds_read_b128 v[104:107], v11 offset:24576
  v_mfma_f32_16x16x32_bf16 v[244:247], v[108:111], v[40:43], v[244:247]
  v_mfma_f32_16x16x32_bf16 v[248:251], v[108:111], v[44:47], v[248:251]
  v_mfma_f32_16x16x32_bf16 v[252:255], v[108:111], v[48:51], v[252:255]
  s_waitcnt lgkmcnt(3)
  v_mfma_f32_16x16x32_bf16 v[112:115], v[52:55], v[80:83], v[112:115]
  ds_read_b128 v[108:111], v11 offset:25600
  v_mfma_f32_16x16x32_bf16 v[116:119], v[56:59], v[80:83], v[116:119]
  v_mfma_f32_16x16x32_bf16 v[120:123], v[60:63], v[80:83], v[120:123]
  v_mfma_f32_16x16x32_bf16 v[124:127], v[64:67], v[80:83], v[124:127]
  s_add_u32 m0, s40, 0
  s_nop 0
  buffer_load_dwordx4 v14, s[16:19], s56 offen offset:0 lds
  s_waitcnt lgkmcnt(4)
  v_mfma_f32_16x16x32_bf16 v[128:131], v[52:55], v[84:87], v[128:131]
  ds_read_b128 v[80:83], v10 offset:26624
  v_mfma_f32_16x16x32_bf16 v[132:135], v[56:59], v[84:87], v[132:135]
  v_mfma_f32_16x16x32_bf16 v[136:139], v[60:63], v[84:87], v[136:139]
  v_mfma_f32_16x16x32_bf16 v[140:143], v[64:67], v[84:87], v[140:143]
  buffer_load_dwordx4 v15, s[16:19], s57 offen offset:1024 lds
  s_waitcnt lgkmcnt(5)
  v_mfma_f32_16x16x32_bf16 v[144:147], v[52:55], v[88:91], v[144:147]
  ds_read_b128 v[84:87], v10 offset:27648
  v_mfma_f32_16x16x32_bf16 v[148:151], v[56:59], v[88:91], v[148:151]
  ds_read_b128 v[20:23], v13 offset:8192
  v_mfma_f32_16x16x32_bf16 v[152:155], v[60:63], v[88:91], v[152:155]
  v_mfma_f32_16x16x32_bf16 v[156:159], v[64:67], v[88:91], v[156:159]
  s_waitcnt lgkmcnt(7)
  v_mfma_f32_16x16x32_bf16 v[160:163], v[52:55], v[92:95], v[160:163]
  ds_read_b128 v[88:91], v10 offset:28672
  v_mfma_f32_16x16x32_bf16 v[164:167], v[56:59], v[92:95], v[164:167]
  ds_read_b128 v[24:27], v13 offset:10240
  v_mfma_f32_16x16x32_bf16 v[168:171], v[60:63], v[92:95], v[168:171]
  v_mfma_f32_16x16x32_bf16 v[172:175], v[64:67], v[92:95], v[172:175]
  buffer_load_dwordx4 v14, s[16:19], s58 offen offset:2048 lds
  s_waitcnt lgkmcnt(8)
  v_mfma_f32_16x16x32_bf16 v[176:179], v[52:55], v[96:99], v[176:179]
  ds_read_b128 v[92:95], v10 offset:29696
  v_mfma_f32_16x16x32_bf16 v[180:183], v[56:59], v[96:99], v[180:183]
  ds_read_b128 v[28:31], v13 offset:12288
  v_mfma_f32_16x16x32_bf16 v[184:187], v[60:63], v[96:99], v[184:187]
  v_mfma_f32_16x16x32_bf16 v[188:191], v[64:67], v[96:99], v[188:191]
  buffer_load_dwordx4 v15, s[16:19], s59 offen offset:3072 lds
  s_waitcnt lgkmcnt(9)
  v_mfma_f32_16x16x32_bf16 v[192:195], v[52:55], v[100:103], v[192:195]
  ds_read_b128 v[96:99], v10 offset:30720
  v_mfma_f32_16x16x32_bf16 v[196:199], v[56:59], v[100:103], v[196:199]
  ds_read_b128 v[32:35], v13 offset:14336
  v_mfma_f32_16x16x32_bf16 v[200:203], v[60:63], v[100:103], v[200:203]
  v_mfma_f32_16x16x32_bf16 v[204:207], v[64:67], v[100:103], v[204:207]
  s_waitcnt lgkmcnt(10)
  v_mfma_f32_16x16x32_bf16 v[208:211], v[52:55], v[104:107], v[208:211]
  ds_read_b128 v[100:103], v11 offset:31744
  v_mfma_f32_16x16x32_bf16 v[212:215], v[56:59], v[104:107], v[212:215]
  v_mfma_f32_16x16x32_bf16 v[216:219], v[60:63], v[104:107], v[216:219]
  v_mfma_f32_16x16x32_bf16 v[220:223], v[64:67], v[104:107], v[220:223]
  s_add_u32 m0, s40, 4096
  s_nop 0
  buffer_load_dwordx4 v14, s[16:19], s60 offen offset:0 lds
  s_waitcnt lgkmcnt(10)
  v_mfma_f32_16x16x32_bf16 v[224:227], v[52:55], v[108:111], v[224:227]
  ds_read_b128 v[104:107], v11 offset:32768
  v_mfma_f32_16x16x32_bf16 v[228:231], v[56:59], v[108:111], v[228:231]
  v_mfma_f32_16x16x32_bf16 v[232:235], v[60:63], v[108:111], v[232:235]
  v_mfma_f32_16x16x32_bf16 v[236:239], v[64:67], v[108:111], v[236:239]
  buffer_load_dwordx4 v15, s[16:19], s61 offen offset:1024 lds
  s_waitcnt lgkmcnt(10)
  v_mfma_f32_16x16x32_bf16 v[240:243], v[80:83], v[52:55], v[240:243]
  ds_read_b128 v[108:111], v11 offset:33792
  v_mfma_f32_16x16x32_bf16 v[244:247], v[80:83], v[56:59], v[244:247]
  v_mfma_f32_16x16x32_bf16 v[248:251], v[80:83], v[60:63], v[248:251]
  v_mfma_f32_16x16x32_bf16 v[252:255], v[80:83], v[64:67], v[252:255]
  s_waitcnt lgkmcnt(3)
  v_mfma_f32_16x16x32_bf16 v[112:115], v[20:23], v[84:87], v[112:115]
  ds_read_b128 v[80:83], v11 offset:34816
  v_mfma_f32_16x16x32_bf16 v[116:119], v[24:27], v[84:87], v[116:119]
  v_mfma_f32_16x16x32_bf16 v[120:123], v[28:31], v[84:87], v[120:123]
  v_mfma_f32_16x16x32_bf16 v[124:127], v[32:35], v[84:87], v[124:127]
  buffer_load_dwordx4 v14, s[16:19], s62 offen offset:2048 lds
  s_waitcnt lgkmcnt(4)
  v_mfma_f32_16x16x32_bf16 v[128:131], v[20:23], v[88:91], v[128:131]
  ds_read_b128 v[84:87], v10 offset:35840
  v_mfma_f32_16x16x32_bf16 v[132:135], v[24:27], v[88:91], v[132:135]
  v_mfma_f32_16x16x32_bf16 v[136:139], v[28:31], v[88:91], v[136:139]
  v_mfma_f32_16x16x32_bf16 v[140:143], v[32:35], v[88:91], v[140:143]
  buffer_load_dwordx4 v15, s[16:19], s63 offen offset:3072 lds
  v_add_u32 v14, 128, v14
  v_add_u32 v15, 128, v15
  s_waitcnt lgkmcnt(5)
  v_mfma_f32_16x16x32_bf16 v[144:147], v[20:23], v[92:95], v[144:147]
  s_waitcnt vmcnt(8)
  s_barrier
  ds_read_b128 v[88:91], v10 offset:36864
  v_mfma_f32_16x16x32_bf16 v[148:151], v[24:27], v[92:95], v[148:151]
  ds_read_b128 v[36:39], v12 offset:16384
  v_mfma_f32_16x16x32_bf16 v[152:155], v[28:31], v[92:95], v[152:155]
  v_mfma_f32_16x16x32_bf16 v[156:159], v[32:35], v[92:95], v[156:159]
  s_waitcnt lgkmcnt(7)
  v_mfma_f32_16x16x32_bf16 v[160:163], v[20:23], v[96:99], v[160:163]
  ds_read_b128 v[92:95], v10 offset:37888
  v_mfma_f32_16x16x32_bf16 v[164:167], v[24:27], v[96:99], v[164:167]
  ds_read_b128 v[40:43], v12 offset:18432
  v_mfma_f32_16x16x32_bf16 v[168:171], v[28:31], v[96:99], v[168:171]
  v_mfma_f32_16x16x32_bf16 v[172:175], v[32:35], v[96:99], v[172:175]
  s_waitcnt lgkmcnt(8)
  v_mfma_f32_16x16x32_bf16 v[176:179], v[20:23], v[100:103], v[176:179]
  ds_read_b128 v[96:99], v10 offset:38912
  v_mfma_f32_16x16x32_bf16 v[180:183], v[24:27], v[100:103], v[180:183]
  ds_read_b128 v[44:47], v12 offset:20480
  v_mfma_f32_16x16x32_bf16 v[184:187], v[28:31], v[100:103], v[184:187]
  v_mfma_f32_16x16x32_bf16 v[188:191], v[32:35], v[100:103], v[188:191]
  s_waitcnt lgkmcnt(9)
  v_mfma_f32_16x16x32_bf16 v[192:195], v[20:23], v[104:107], v[192:195]
  ds_read_b128 v[100:103], v10 offset:39936
  v_mfma_f32_16x16x32_bf16 v[196:199], v[24:27], v[104:107], v[196:199]
  ds_read_b128 v[48:51], v12 offset:22528
  v_mfma_f32_16x16x32_bf16 v[200:203], v[28:31], v[104:107], v[200:203]
  v_mfma_f32_16x16x32_bf16 v[204:207], v[32:35], v[104:107], v[204:207]
  s_waitcnt lgkmcnt(10)
  v_mfma_f32_16x16x32_bf16 v[208:211], v[20:23], v[108:111], v[208:211]
  ds_read_b128 v[104:107], v11 offset:40960
  v_mfma_f32_16x16x32_bf16 v[212:215], v[24:27], v[108:111], v[212:215]
  v_mfma_f32_16x16x32_bf16 v[216:219], v[28:31], v[108:111], v[216:219]
  v_mfma_f32_16x16x32_bf16 v[220:223], v[32:35], v[108:111], v[220:223]
  s_waitcnt lgkmcnt(10)
  v_mfma_f32_16x16x32_bf16 v[224:227], v[20:23], v[80:83], v[224:227]
  ds_read_b128 v[108:111], v11 offset:41984
  v_mfma_f32_16x16x32_bf16 v[228:231], v[24:27], v[80:83], v[228:231]
  v_mfma_f32_16x16x32_bf16 v[232:235], v[28:31], v[80:83], v[232:235]
  v_mfma_f32_16x16x32_bf16 v[236:239], v[32:35], v[80:83], v[236:239]
  s_waitcnt lgkmcnt(10)
  v_mfma_f32_16x16x32_bf16 v[240:243], v[84:87], v[20:23], v[240:243]
  ds_read_b128 v[80:83], v11 offset:43008
  v_mfma_f32_16x16x32_bf16 v[244:247], v[84:87], v[24:27], v[244:247]
  v_mfma_f32_16x16x32_bf16 v[248:251], v[84:87], v[28:31], v[248:251]
  v_mfma_f32_16x16x32_bf16 v[252:255], v[84:87], v[32:35], v[252:255]
  s_waitcnt lgkmcnt(3)
  v_mfma_f32_16x16x32_bf16 v[112:115], v[36:39], v[88:91], v[112:115]
  ds_read_b128 v[84:87], v11 offset:44032
  v_mfma_f32_16x16x32_bf16 v[116:119], v[40:43], v[88:91], v[116:119]
  v_mfma_f32_16x16x32_bf16 v[120:123], v[44:47], v[88:91], v[120:123]
  v_mfma_f32_16x16x32_bf16 v[124:127], v[48:51], v[88:91], v[124:127]
  s_add_u32 m0, s40, 8192
  s_nop 0
  buffer_load_dwordx4 v14, s[16:19], s56 offen offset:0 lds
  s_waitcnt lgkmcnt(4)
  v_mfma_f32_16x16x32_bf16 v[128:131], v[36:39], v[92:95], v[128:131]
  ds_read_b128 v[88:91], v10 offset:45056
  v_mfma_f32_16x16x32_bf16 v[132:135], v[40:43], v[92:95], v[132:135]
  v_mfma_f32_16x16x32_bf16 v[136:139], v[44:47], v[92:95], v[136:139]
  v_mfma_f32_16x16x32_bf16 v[140:143], v[48:51], v[92:95], v[140:143]
  buffer_load_dwordx4 v15, s[16:19], s57 offen offset:1024 lds
  s_waitcnt lgkmcnt(5)
  v_mfma_f32_16x16x32_bf16 v[144:147], v[36:39], v[96:99], v[144:147]
  ds_read_b128 v[92:95], v10 offset:46080
  v_mfma_f32_16x16x32_bf16 v[148:151], v[40:43], v[96:99], v[148:151]
  ds_read_b128 v[52:55], v13 offset:16384
  v_mfma_f32_16x16x32_bf16 v[152:155], v[44:47], v[96:99], v[152:155]
  v_mfma_f32_16x16x32_bf16 v[156:159], v[48:51], v[96:99], v[156:159]
  s_waitcnt lgkmcnt(7)
  v_mfma_f32_16x16x32_bf16 v[160:163], v[36:39], v[100:103], v[160:163]
  ds_read_b128 v[96:99], v10 offset:47104
  v_mfma_f32_16x16x32_bf16 v[164:167], v[40:43], v[100:103], v[164:167]
  ds_read_b128 v[56:59], v13 offset:18432
  v_mfma_f32_16x16x32_bf16 v[168:171], v[44:47], v[100:103], v[168:171]
  v_mfma_f32_16x16x32_bf16 v[172:175], v[48:51], v[100:103], v[172:175]
  buffer_load_dwordx4 v14, s[16:19], s58 offen offset:2048 lds
  s_waitcnt lgkmcnt(8)
  v_mfma_f32_16x16x32_bf16 v[176:179], v[36:39], v[104:107], v[176:179]
  ds_read_b128 v[100:103], v10 offset:48128
  v_mfma_f32_16x16x32_bf16 v[180:183], v[40:43], v[104:107], v[180:183]
  ds_read_b128 v[60:63], v13 offset:20480
  v_mfma_f32_16x16x32_bf16 v[184:187], v[44:47], v[104:107], v[184:187]
  v_mfma_f32_16x16x32_bf16 v[188:191], v[48:51], v[104:107], v[188:191]
  buffer_load_dwordx4 v15, s[16:19], s59 offen offset:3072 lds
  s_waitcnt lgkmcnt(9)
  v_mfma_f32_16x16x32_bf16 v[192:195], v[36:39], v[108:111], v[192:195]
  ds_read_b128 v[104:107], v10 offset:49152
  v_mfma_f32_16x16x32_bf16 v[196:199], v[40:43], v[108:111], v[196:199]
  ds_read_b128 v[64:67], v13 offset:22528
  v_mfma_f32_16x16x32_bf16 v[200:203], v[44:47], v[108:111], v[200:203]
  v_mfma_f32_16x16x32_bf16 v[204:207], v[48:51], v[108:111], v[204:207]
  s_waitcnt lgkmcnt(10)
  v_mfma_f32_16x16x32_bf16 v[208:211], v[36:39], v[80:83], v[208:211]
  ds_read_b128 v[108:111], v11 offset:50176
  v_mfma_f32_16x16x32_bf16 v[212:215], v[40:43], v[80:83], v[212:215]
  v_mfma_f32_16x16x32_bf16 v[216:219], v[44:47], v[80:83], v[216:219]
  v_mfma_f32_16x16x32_bf16 v[220:223], v[48:51], v[80:83], v[220:223]
  s_add_u32 m0, s40, 12288
  s_nop 0
  buffer_load_dwordx4 v14, s[16:19], s60 offen offset:0 lds
  s_waitcnt lgkmcnt(10)
  v_mfma_f32_16x16x32_bf16 v[224:227], v[36:39], v[84:87], v[224:227]
  ds_read_b128 v[80:83], v11 offset:51200
  v_mfma_f32_16x16x32_bf16 v[228:231], v[40:43], v[84:87], v[228:231]
  v_mfma_f32_16x16x32_bf16 v[232:235], v[44:47], v[84:87], v[232:235]
  v_mfma_f32_16x16x32_bf16 v[236:239], v[48:51], v[84:87], v[236:239]
  buffer_load_dwordx4 v15, s[16:19], s61 offen offset:1024 lds
  s_waitcnt lgkmcnt(10)
  v_mfma_f32_16x16x32_bf16 v[240:243], v[88:91], v[36:39], v[240:243]
  ds_read_b128 v[84:87], v11 offset:52224
  v_mfma_f32_16x16x32_bf16 v[244:247], v[88:91], v[40:43], v[244:247]
  v_mfma_f32_16x16x32_bf16 v[248:251], v[88:91], v[44:47], v[248:251]
  v_mfma_f32_16x16x32_bf16 v[252:255], v[88:91], v[48:51], v[252:255]
  s_waitcnt lgkmcnt(3)
  v_mfma_f32_16x16x32_bf16 v[112:115], v[52:55], v[92:95], v[112:115]
  ds_read_b128 v[88:91], v11 offset:53248
  v_mfma_f32_16x16x32_bf16 v[116:119], v[56:59], v[92:95], v[116:119]
  v_mfma_f32_16x16x32_bf16 v[120:123], v[60:63], v[92:95], v[120:123]
  v_mfma_f32_16x16x32_bf16 v[124:127], v[64:67], v[92:95], v[124:127]
  buffer_load_dwordx4 v14, s[16:19], s62 offen offset:2048 lds
  s_waitcnt lgkmcnt(4)
  v_mfma_f32_16x16x32_bf16 v[128:131], v[52:55], v[96:99], v[128:131]
  ds_read_b128 v[92:95], v10 offset:54272
  v_mfma_f32_16x16x32_bf16 v[132:135], v[56:59], v[96:99], v[132:135]
  v_mfma_f32_16x16x32_bf16 v[136:139], v[60:63], v[96:99], v[136:139]
  v_mfma_f32_16x16x32_bf16 v[140:143], v[64:67], v[96:99], v[140:143]
  buffer_load_dwordx4 v15, s[16:19], s63 offen offset:3072 lds
  v_add_u32 v14, 128, v14
  v_add_u32 v15, 128, v15
  s_waitcnt lgkmcnt(5)
  v_mfma_f32_16x16x32_bf16 v[144:147], v[52:55], v[100:103], v[144:147]
  s_waitcnt vmcnt(8)
  s_barrier
  ds_read_b128 v[96:99], v10 offset:0
  v_mfma_f32_16x16x32_bf16 v[148:151], v[56:59], v[100:103], v[148:151]
  ds_read_b128 v[20:23], v12 offset:0
  v_mfma_f32_16x16x32_bf16 v[152:155], v[60:63], v[100:103], v[152:155]
  v_mfma_f32_16x16x32_bf16 v[156:159], v[64:67], v[100:103], v[156:159]
  s_waitcnt lgkmcnt(7)
  v_mfma_f32_16x16x32_bf16 v[160:163], v[52:55], v[104:107], v[160:163]
  ds_read_b128 v[100:103], v10 offset:1024
  v_mfma_f32_16x16x32_bf16 v[164:167], v[56:59], v[104:107], v[164:167]
  ds_read_b128 v[24:27], v12 offset:2048
  v_mfma_f32_16x16x32_bf16 v[168:171], v[60:63], v[104:107], v[168:171]
  v_mfma_f32_16x16x32_bf16 v[172:175], v[64:67], v[104:107], v[172:175]
  s_waitcnt lgkmcnt(8)
  v_mfma_f32_16x16x32_bf16 v[176:179], v[52:55], v[108:111], v[176:179]
  ds_read_b128 v[104:107], v10 offset:2048
  v_mfma_f32_16x16x32_bf16 v[180:183], v[56:59], v[108:111], v[180:183]
  ds_read_b128 v[28:31], v12 offset:4096
  v_mfma_f32_16x16x32_bf16 v[184:187], v[60:63], v[108:111], v[184:187]
  v_mfma_f32_16x16x32_bf16 v[188:191], v[64:67], v[108:111], v[188:191]
  s_waitcnt lgkmcnt(9)
  v_mfma_f32_16x16x32_bf16 v[192:195], v[52:55], v[80:83], v[192:195]
  ds_read_b128 v[108:111], v10 offset:3072
  v_mfma_f32_16x16x32_bf16 v[196:199], v[56:59], v[80:83], v[196:199]
  ds_read_b128 v[32:35], v12 offset:6144
  v_mfma_f32_16x16x32_bf16 v[200:203], v[60:63], v[80:83], v[200:203]
  v_mfma_f32_16x16x32_bf16 v[204:207], v[64:67], v[80:83], v[204:207]
  s_waitcnt lgkmcnt(10)
  v_mfma_f32_16x16x32_bf16 v[208:211], v[52:55], v[84:87], v[208:211]
  ds_read_b128 v[80:83], v11 offset:4096
  v_mfma_f32_16x16x32_bf16 v[212:215], v[56:59], v[84:87], v[212:215]
  v_mfma_f32_16x16x32_bf16 v[216:219], v[60:63], v[84:87], v[216:219]
  v_mfma_f32_16x16x32_bf16 v[220:223], v[64:67], v[84:87], v[220:223]
  s_waitcnt lgkmcnt(10)
  v_mfma_f32_16x16x32_bf16 v[224:227], v[52:55], v[88:91], v[224:227]
  ds_read_b128 v[84:87], v11 offset:5120
  v_mfma_f32_16x16x32_bf16 v[228:231], v[56:59], v[88:91], v[228:231]
  v_mfma_f32_16x16x32_bf16 v[232:235], v[60:63], v[88:91], v[232:235]
  v_mfma_f32_16x16x32_bf16 v[236:239], v[64:67], v[88:91], v[236:239]
  s_waitcnt lgkmcnt(10)
  v_mfma_f32_16x16x32_bf16 v[240:243], v[92:95], v[52:55], v[240:243]
  ds_read_b128 v[88:91], v11 offset:6144
  v_mfma_f32_16x16x32_bf16 v[244:247], v[92:95], v[56:59], v[244:247]
  v_mfma_f32_16x16x32_bf16 v[248:251], v[92:95], v[60:63], v[248:251]
  v_mfma_f32_16x16x32_bf16 v[252:255], v[92:95], v[64:67], v[252:255]
  s_waitcnt lgkmcnt(3)
  v_mfma_f32_16x16x32_bf16 v[112:115], v[20:23], v[96:99], v[112:115]
  ds_read_b128 v[92:95], v11 offset:7168
  v_mfma_f32_16x16x32_bf16 v[116:119], v[24:27], v[96:99], v[116:119]
  v_mfma_f32_16x16x32_bf16 v[120:123], v[28:31], v[96:99], v[120:123]
  v_mfma_f32_16x16x32_bf16 v[124:127], v[32:35], v[96:99], v[124:127]
  s_add_u32 m0, s40, 16384
  s_nop 0
  buffer_load_dwordx4 v14, s[16:19], s56 offen offset:0 lds
  s_waitcnt lgkmcnt(4)
  v_mfma_f32_16x16x32_bf16 v[128:131], v[20:23], v[100:103], v[128:131]
  ds_read_b128 v[96:99], v10 offset:8192
  v_mfma_f32_16x16x32_bf16 v[132:135], v[24:27], v[100:103], v[132:135]
  v_mfma_f32_16x16x32_bf16 v[136:139], v[28:31], v[100:103], v[136:139]
  v_mfma_f32_16x16x32_bf16 v[140:143], v[32:35], v[100:103], v[140:143]
  buffer_load_dwordx4 v15, s[16:19], s57 offen offset:1024 lds
  s_waitcnt lgkmcnt(5)
  v_mfma_f32_16x16x32_bf16 v[144:147], v[20:23], v[104:107], v[144:147]
  ds_read_b128 v[100:103], v10 offset:9216
  v_mfma_f32_16x16x32_bf16 v[148:151], v[24:27], v[104:107], v[148:151]
  ds_read_b128 v[36:39], v13 offset:0
  v_mfma_f32_16x16x32_bf16 v[152:155], v[28:31], v[104:107], v[152:155]
  v_mfma_f32_16x16x32_bf16 v[156:159], v[32:35], v[104:107], v[156:159]
  s_waitcnt lgkmcnt(7)
  v_mfma_f32_16x16x32_bf16 v[160:163], v[20:23], v[108:111], v[160:163]
  ds_read_b128 v[104:107], v10 offset:10240
  v_mfma_f32_16x16x32_bf16 v[164:167], v[24:27], v[108:111], v[164:167]
  ds_read_b128 v[40:43], v13 offset:2048
  v_mfma_f32_16x16x32_bf16 v[168:171], v[28:31], v[108:111], v[168:171]
  v_mfma_f32_16x16x32_bf16 v[172:175], v[32:35], v[108:111], v[172:175]
  buffer_load_dwordx4 v14, s[16:19], s58 offen offset:2048 lds
  s_waitcnt lgkmcnt(8)
  v_mfma_f32_16x16x32_bf16 v[176:179], v[20:23], v[80:83], v[176:179]
  ds_read_b128 v[108:111], v10 offset:11264
  v_mfma_f32_16x16x32_bf16 v[180:183], v[24:27], v[80:83], v[180:183]
  ds_read_b128 v[44:47], v13 offset:4096
  v_mfma_f32_16x16x32_bf16 v[184:187], v[28:31], v[80:83], v[184:187]
  v_mfma_f32_16x16x32_bf16 v[188:191], v[32:35], v[80:83], v[188:191]
  buffer_load_dwordx4 v15, s[16:19], s59 offen offset:3072 lds
  s_waitcnt lgkmcnt(9)
  v_mfma_f32_16x16x32_bf16 v[192:195], v[20:23], v[84:87], v[192:195]
  ds_read_b128 v[80:83], v10 offset:12288
  v_mfma_f32_16x16x32_bf16 v[196:199], v[24:27], v[84:87], v[196:199]
  ds_read_b128 v[48:51], v13 offset:6144
  v_mfma_f32_16x16x32_bf16 v[200:203], v[28:31], v[84:87], v[200:203]
  v_mfma_f32_16x16x32_bf16 v[204:207], v[32:35], v[84:87], v[204:207]
  s_waitcnt lgkmcnt(10)
  v_mfma_f32_16x16x32_bf16 v[208:211], v[20:23], v[88:91], v[208:211]
  ds_read_b128 v[84:87], v11 offset:13312
  v_mfma_f32_16x16x32_bf16 v[212:215], v[24:27], v[88:91], v[212:215]
  v_mfma_f32_16x16x32_bf16 v[216:219], v[28:31], v[88:91], v[216:219]
  v_mfma_f32_16x16x32_bf16 v[220:223], v[32:35], v[88:91], v[220:223]
  s_add_u32 m0, s40, 20480
  s_nop 0
  buffer_load_dwordx4 v14, s[16:19], s60 offen offset:0 lds
  s_waitcnt lgkmcnt(10)
  v_mfma_f32_16x16x32_bf16 v[224:227], v[20:23], v[92:95], v[224:227]
  ds_read_b128 v[88:91], v11 offset:14336
  v_mfma_f32_16x16x32_bf16 v[228:231], v[24:27], v[92:95], v[228:231]
  v_mfma_f32_16x16x32_bf16 v[232:235], v[28:31], v[92:95], v[232:235]
  v_mfma_f32_16x16x32_bf16 v[236:239], v[32:35], v[92:95], v[236:239]
  buffer_load_dwordx4 v15, s[16:19], s61 offen offset:1024 lds
  s_waitcnt lgkmcnt(10)
  v_mfma_f32_16x16x32_bf16 v[240:243], v[96:99], v[20:23], v[240:243]
  ds_read_b128 v[92:95], v11 offset:15360
  v_mfma_f32_16x16x32_bf16 v[244:247], v[96:99], v[24:27], v[244:247]
  v_mfma_f32_16x16x32_bf16 v[248:251], v[96:99], v[28:31], v[248:251]
  v_mfma_f32_16x16x32_bf16 v[252:255], v[96:99], v[32:35], v[252:255]
  s_waitcnt lgkmcnt(3)
  v_mfma_f32_16x16x32_bf16 v[112:115], v[36:39], v[100:103], v[112:115]
  ds_read_b128 v[96:99], v11 offset:16384
  v_mfma_f32_16x16x32_bf16 v[116:119], v[40:43], v[100:103], v[116:119]
  v_mfma_f32_16x16x32_bf16 v[120:123], v[44:47], v[100:103], v[120:123]
  v_mfma_f32_16x16x32_bf16 v[124:127], v[48:51], v[100:103], v[124:127]
  buffer_load_dwordx4 v14, s[16:19], s62 offen offset:2048 lds
  s_waitcnt lgkmcnt(4)
  v_mfma_f32_16x16x32_bf16 v[128:131], v[36:39], v[104:107], v[128:131]
  ds_read_b128 v[100:103], v10 offset:17408
  v_mfma_f32_16x16x32_bf16 v[132:135], v[40:43], v[104:107], v[132:135]
  v_mfma_f32_16x16x32_bf16 v[136:139], v[44:47], v[104:107], v[136:139]
  v_mfma_f32_16x16x32_bf16 v[140:143], v[48:51], v[104:107], v[140:143]
  buffer_load_dwordx4 v15, s[16:19], s63 offen offset:3072 lds
  v_add_u32 v14, 128, v14
  v_add_u32 v15, 128, v15
  s_waitcnt lgkmcnt(5)
  v_mfma_f32_16x16x32_bf16 v[144:147], v[36:39], v[108:111], v[144:147]
  s_waitcnt vmcnt(8)
  s_barrier
  ds_read_b128 v[104:107], v10 offset:18432
  v_mfma_f32_16x16x32_bf16 v[148:151], v[40:43], v[108:111], v[148:151]
  ds_read_b128 v[52:55], v12 offset:8192
  v_mfma_f32_16x16x32_bf16 v[152:155], v[44:47], v[108:111], v[152:155]
  v_mfma_f32_16x16x32_bf16 v[156:159], v[48:51], v[108:111], v[156:159]
  s_waitcnt lgkmcnt(7)
  v_mfma_f32_16x16x32_bf16 v[160:163], v[36:39], v[80:83], v[160:163]
  ds_read_b128 v[108:111], v10 offset:19456
  v_mfma_f32_16x16x32_bf16 v[164:167], v[40:43], v[80:83], v[164:167]
  ds_read_b128 v[56:59], v12 offset:10240
  v_mfma_f32_16x16x32_bf16 v[168:171], v[44:47], v[80:83], v[168:171]
  v_mfma_f32_16x16x32_bf16 v[172:175], v[48:51], v[80:83], v[172:175]
  s_waitcnt lgkmcnt(8)
  v_mfma_f32_16x16x32_bf16 v[176:179], v[36:39], v[84:87], v[176:179]
  ds_read_b128 v[80:83], v10 offset:20480
  v_mfma_f32_16x16x32_bf16 v[180:183], v[40:43], v[84:87], v[180:183]
  v_mfma_f32_16x16x32_bf16 v[184:187], v[44:47], v[84:87], v[184:187]
  v_mfma_f32_16x16x32_bf16 v[188:191], v[48:51], v[84:87], v[188:191]
  s_waitcnt lgkmcnt(8)
  v_mfma_f32_16x16x32_bf16 v[192:195], v[36:39], v[88:91], v[192:195]
  ds_read_b128 v[84:87], v10 offset:21504
  v_mfma_f32_16x16x32_bf16 v[196:199], v[40:43], v[88:91], v[196:199]
  v_mfma_f32_16x16x32_bf16 v[200:203], v[44:47], v[88:91], v[200:203]
  v_mfma_f32_16x16x32_bf16 v[204:207], v[48:51], v[88:91], v[204:207]
  s_waitcnt lgkmcnt(8)
  v_mfma_f32_16x16x32_bf16 v[208:211], v[36:39], v[92:95], v[208:211]
  ds_read_b128 v[88:91], v11 offset:22528
  v_mfma_f32_16x16x32_bf16 v[212:215], v[40:43], v[92:95], v[212:215]
  v_mfma_f32_16x16x32_bf16 v[216:219], v[44:47], v[92:95], v[216:219]
  v_mfma_f32_16x16x32_bf16 v[220:223], v[48:51], v[92:95], v[220:223]
  s_waitcnt lgkmcnt(8)
  v_mfma_f32_16x16x32_bf16 v[224:227], v[36:39], v[96:99], v[224:227]
  ds_read_b128 v[92:95], v11 offset:23552
  v_mfma_f32_16x16x32_bf16 v[228:231], v[40:43], v[96:99], v[228:231]
  v_mfma_f32_16x16x32_bf16 v[232:235], v[44:47], v[96:99], v[232:235]
  v_mfma_f32_16x16x32_bf16 v[236:239], v[48:51], v[96:99], v[236:239]
  s_waitcnt lgkmcnt(8)
  v_mfma_f32_16x16x32_bf16 v[240:243], v[100:103], v[36:39], v[240:243]
  ds_read_b128 v[96:99], v11 offset:24576
  v_mfma_f32_16x16x32_bf16 v[244:247], v[100:103], v[40:43], v[244:247]
  v_mfma_f32_16x16x32_bf16 v[248:251], v[100:103], v[44:47], v[248:251]
  v_mfma_f32_16x16x32_bf16 v[252:255], v[100:103], v[48:51], v[252:255]
  s_waitcnt lgkmcnt(5)
  v_mfma_f32_16x16x32_bf16 v[112:115], v[52:55], v[104:107], v[112:115]
  ds_read_b128 v[100:103], v11 offset:25600
  v_mfma_f32_16x16x32_bf16 v[116:119], v[56:59], v[104:107], v[116:119]
  s_waitcnt lgkmcnt(6)
  v_mfma_f32_16x16x32_bf16 v[128:131], v[52:55], v[108:111], v[128:131]
  ds_read_b128 v[104:107], v10 offset:26624
  v_mfma_f32_16x16x32_bf16 v[132:135], v[56:59], v[108:111], v[132:135]
  s_waitcnt lgkmcnt(6)
  v_mfma_f32_16x16x32_bf16 v[144:147], v[52:55], v[80:83], v[144:147]
  ds_read_b128 v[108:111], v10 offset:27648
  v_mfma_f32_16x16x32_bf16 v[148:151], v[56:59], v[80:83], v[148:151]
  ds_read_b128 v[60:63], v13 offset:8192
  s_waitcnt lgkmcnt(7)
  v_mfma_f32_16x16x32_bf16 v[160:163], v[52:55], v[84:87], v[160:163]
  ds_read_b128 v[80:83], v10 offset:28672
  v_mfma_f32_16x16x32_bf16 v[164:167], v[56:59], v[84:87], v[164:167]
  ds_read_b128 v[64:67], v13 offset:10240
  s_waitcnt lgkmcnt(8)
  v_mfma_f32_16x16x32_bf16 v[176:179], v[52:55], v[88:91], v[176:179]
  ds_read_b128 v[84:87], v10 offset:29696
  v_mfma_f32_16x16x32_bf16 v[180:183], v[56:59], v[88:91], v[180:183]
  s_waitcnt lgkmcnt(8)
  v_mfma_f32_16x16x32_bf16 v[192:195], v[52:55], v[92:95], v[192:195]
  ds_read_b128 v[88:91], v10 offset:30720
  v_mfma_f32_16x16x32_bf16 v[196:199], v[56:59], v[92:95], v[196:199]
  s_waitcnt lgkmcnt(8)
  v_mfma_f32_16x16x32_bf16 v[208:211], v[52:55], v[96:99], v[208:211]
  ds_read_b128 v[92:95], v11 offset:31744
  v_mfma_f32_16x16x32_bf16 v[212:215], v[56:59], v[96:99], v[212:215]
  s_waitcnt lgkmcnt(8)
  v_mfma_f32_16x16x32_bf16 v[224:227], v[52:55], v[100:103], v[224:227]
  ds_read_b128 v[96:99], v11 offset:32768
  v_mfma_f32_16x16x32_bf16 v[228:231], v[56:59], v[100:103], v[228:231]
  s_waitcnt lgkmcnt(8)
  v_mfma_f32_16x16x32_bf16 v[240:243], v[104:107], v[52:55], v[240:243]
  ds_read_b128 v[100:103], v11 offset:33792
  v_mfma_f32_16x16x32_bf16 v[244:247], v[104:107], v[56:59], v[244:247]
  s_waitcnt lgkmcnt(5)
  v_mfma_f32_16x16x32_bf16 v[112:115], v[60:63], v[108:111], v[112:115]
  ds_read_b128 v[104:107], v11 offset:34816
  v_mfma_f32_16x16x32_bf16 v[116:119], v[64:67], v[108:111], v[116:119]
  s_waitcnt lgkmcnt(6)
  v_mfma_f32_16x16x32_bf16 v[128:131], v[60:63], v[80:83], v[128:131]
  ds_read_b128 v[108:111], v10 offset:35840
  v_mfma_f32_16x16x32_bf16 v[132:135], v[64:67], v[80:83], v[132:135]
  s_waitcnt lgkmcnt(6)
  v_mfma_f32_16x16x32_bf16 v[144:147], v[60:63], v[84:87], v[144:147]
  s_waitcnt vmcnt(0)
  s_barrier
  ds_read_b128 v[80:83], v10 offset:36864
  v_mfma_f32_16x16x32_bf16 v[148:151], v[64:67], v[84:87], v[148:151]
  ds_read_b128 v[20:23], v12 offset:16384
  s_waitcnt lgkmcnt(7)
  v_mfma_f32_16x16x32_bf16 v[160:163], v[60:63], v[88:91], v[160:163]
  ds_read_b128 v[84:87], v10 offset:37888
  v_mfma_f32_16x16x32_bf16 v[164:167], v[64:67], v[88:91], v[164:167]
  ds_read_b128 v[24:27], v12 offset:18432
  s_waitcnt lgkmcnt(8)
  v_mfma_f32_16x16x32_bf16 v[176:179], v[60:63], v[92:95], v[176:179]
  ds_read_b128 v[88:91], v10 offset:38912
  v_mfma_f32_16x16x32_bf16 v[180:183], v[64:67], v[92:95], v[180:183]
  s_waitcnt lgkmcnt(8)
  v_mfma_f32_16x16x32_bf16 v[192:195], v[60:63], v[96:99], v[192:195]
  ds_read_b128 v[92:95], v10 offset:39936
  v_mfma_f32_16x16x32_bf16 v[196:199], v[64:67], v[96:99], v[196:199]
  s_waitcnt lgkmcnt(8)
  v_mfma_f32_16x16x32_bf16 v[208:211], v[60:63], v[100:103], v[208:211]
  ds_read_b128 v[96:99], v11 offset:40960
  v_mfma_f32_16x16x32_bf16 v[212:215], v[64:67], v[100:103], v[212:215]
  s_waitcnt lgkmcnt(8)
  v_mfma_f32_16x16x32_bf16 v[224:227], v[60:63], v[104:107], v[224:227]
  ds_read_b128 v[100:103], v11 offset:41984
  v_mfma_f32_16x16x32_bf16 v[228:231], v[64:67], v[104:107], v[228:231]
  s_waitcnt lgkmcnt(8)
  v_mfma_f32_16x16x32_bf16 v[240:243], v[108:111], v[60:63], v[240:243]
  ds_read_b128 v[104:107], v11 offset:43008
  v_mfma_f32_16x16x32_bf16 v[244:247], v[108:111], v[64:67], v[244:247]
  s_waitcnt lgkmcnt(5)
  v_mfma_f32_16x16x32_bf16 v[112:115], v[20:23], v[80:83], v[112:115]
  ds_read_b128 v[108:111], v11 offset:44032
  v_mfma_f32_16x16x32_bf16 v[116:119], v[24:27], v[80:83], v[116:119]
  s_waitcnt lgkmcnt(6)
  v_mfma_f32_16x16x32_bf16 v[128:131], v[20:23], v[84:87], v[128:131]
  ds_read_b128 v[80:83], v10 offset:45056
  v_mfma_f32_16x16x32_bf16 v[132:135], v[24:27], v[84:87], v[132:135]
  s_waitcnt lgkmcnt(6)
  v_mfma_f32_16x16x32_bf16 v[144:147], v[20:23], v[88:91], v[144:147]
  ds_read_b128 v[84:87], v10 offset:46080
  v_mfma_f32_16x16x32_bf16 v[148:151], v[24:27], v[88:91], v[148:151]
  ds_read_b128 v[28:31], v13 offset:16384
  s_waitcnt lgkmcnt(7)
  v_mfma_f32_16x16x32_bf16 v[160:163], v[20:23], v[92:95], v[160:163]
  ds_read_b128 v[88:91], v10 offset:47104
  v_mfma_f32_16x16x32_bf16 v[164:167], v[24:27], v[92:95], v[164:167]
  ds_read_b128 v[32:35], v13 offset:18432
  s_waitcnt lgkmcnt(8)
  v_mfma_f32_16x16x32_bf16 v[176:179], v[20:23], v[96:99], v[176:179]
  ds_read_b128 v[92:95], v10 offset:48128
  v_mfma_f32_16x16x32_bf16 v[180:183], v[24:27], v[96:99], v[180:183]
  s_waitcnt lgkmcnt(8)
  v_mfma_f32_16x16x32_bf16 v[192:195], v[20:23], v[100:103], v[192:195]
  ds_read_b128 v[96:99], v10 offset:49152
  v_mfma_f32_16x16x32_bf16 v[196:199], v[24:27], v[100:103], v[196:199]
  s_waitcnt lgkmcnt(8)
  v_mfma_f32_16x16x32_bf16 v[208:211], v[20:23], v[104:107], v[208:211]
  ds_read_b128 v[100:103], v11 offset:50176
  v_mfma_f32_16x16x32_bf16 v[212:215], v[24:27], v[104:107], v[212:215]
  s_waitcnt lgkmcnt(8)
  v_mfma_f32_16x16x32_bf16 v[224:227], v[20:23], v[108:111], v[224:227]
  ds_read_b128 v[104:107], v11 offset:51200
  v_mfma_f32_16x16x32_bf16 v[228:231], v[24:27], v[108:111], v[228:231]
  s_waitcnt lgkmcnt(8)
  v_mfma_f32_16x16x32_bf16 v[240:243], v[80:83], v[20:23], v[240:243]
  ds_read_b128 v[108:111], v11 offset:52224
  v_mfma_f32_16x16x32_bf16 v[244:247], v[80:83], v[24:27], v[244:247]
  s_waitcnt lgkmcnt(5)
  v_mfma_f32_16x16x32_bf16 v[112:115], v[28:31], v[84:87], v[112:115]
  ds_read_b128 v[80:83], v11 offset:53248
  v_mfma_f32_16x16x32_bf16 v[116:119], v[32:35], v[84:87], v[116:119]
  s_waitcnt lgkmcnt(6)
  v_mfma_f32_16x16x32_bf16 v[128:131], v[28:31], v[88:91], v[128:131]
  ds_read_b128 v[84:87], v10 offset:54272
  v_mfma_f32_16x16x32_bf16 v[132:135], v[32:35], v[88:91], v[132:135]
  s_waitcnt lgkmcnt(6)
  v_mfma_f32_16x16x32_bf16 v[144:147], v[28:31], v[92:95], v[144:147]
  ds_read_b128 v[88:91], v10 offset:18432
  v_mfma_f32_16x16x32_bf16 v[148:151], v[32:35], v[92:95], v[148:151]
  ds_read_b128 v[36:39], v12 offset:12288
  s_waitcnt lgkmcnt(7)
  v_mfma_f32_16x16x32_bf16 v[160:163], v[28:31], v[96:99], v[160:163]
  ds_read_b128 v[92:95], v10 offset:19456
  v_mfma_f32_16x16x32_bf16 v[164:167], v[32:35], v[96:99], v[164:167]
  ds_read_b128 v[40:43], v12 offset:14336
  s_waitcnt lgkmcnt(8)
  v_mfma_f32_16x16x32_bf16 v[176:179], v[28:31], v[100:103], v[176:179]
  ds_read_b128 v[96:99], v10 offset:20480
  v_mfma_f32_16x16x32_bf16 v[180:183], v[32:35], v[100:103], v[180:183]
  s_waitcnt lgkmcnt(8)
  v_mfma_f32_16x16x32_bf16 v[192:195], v[28:31], v[104:107], v[192:195]
  ds_read_b128 v[100:103], v10 offset:21504
  v_mfma_f32_16x16x32_bf16 v[196:199], v[32:35], v[104:107], v[196:199]
  s_waitcnt lgkmcnt(8)
  v_mfma_f32_16x16x32_bf16 v[208:211], v[28:31], v[108:111], v[208:211]
  ds_read_b128 v[104:107], v11 offset:22528
  v_mfma_f32_16x16x32_bf16 v[212:215], v[32:35], v[108:111], v[212:215]
  s_waitcnt lgkmcnt(8)
  v_mfma_f32_16x16x32_bf16 v[224:227], v[28:31], v[80:83], v[224:227]
  ds_read_b128 v[108:111], v11 offset:23552
  v_mfma_f32_16x16x32_bf16 v[228:231], v[32:35], v[80:83], v[228:231]
  s_waitcnt lgkmcnt(8)
  v_mfma_f32_16x16x32_bf16 v[240:243], v[84:87], v[28:31], v[240:243]
  ds_read_b128 v[80:83], v11 offset:24576
  v_mfma_f32_16x16x32_bf16 v[244:247], v[84:87], v[32:35], v[244:247]
  s_waitcnt lgkmcnt(5)
  v_mfma_f32_16x16x32_bf16 v[120:123], v[36:39], v[88:91], v[120:123]
  ds_read_b128 v[84:87], v11 offset:25600
  v_mfma_f32_16x16x32_bf16 v[124:127], v[40:43], v[88:91], v[124:127]
  s_waitcnt lgkmcnt(6)
  v_mfma_f32_16x16x32_bf16 v[136:139], v[36:39], v[92:95], v[136:139]
  ds_read_b128 v[88:91], v10 offset:26624
  v_mfma_f32_16x16x32_bf16 v[140:143], v[40:43], v[92:95], v[140:143]
  s_waitcnt lgkmcnt(6)
  v_mfma_f32_16x16x32_bf16 v[152:155], v[36:39], v[96:99], v[152:155]
  ds_read_b128 v[92:95], v10 offset:27648
  v_mfma_f32_16x16x32_bf16 v[156:159], v[40:43], v[96:99], v[156:159]
  ds_read_b128 v[44:47], v13 offset:12288
  v_cvt_pk_bf16_f32 v68, v112, v128
  v_cvt_pk_bf16_f32 v69, v144, v160
  v_cvt_pk_bf16_f32 v70, v176, v192
  v_cvt_pk_bf16_f32 v71, v208, v224
  s_mov_b32 s36, 0
  buffer_store_dwordx4 v[68:71], v6, s[28:31], s36 offen
  s_waitcnt lgkmcnt(7)
  v_mfma_f32_16x16x32_bf16 v[168:171], v[36:39], v[100:103], v[168:171]
  ds_read_b128 v[96:99], v10 offset:28672
  v_mfma_f32_16x16x32_bf16 v[172:175], v[40:43], v[100:103], v[172:175]
  ds_read_b128 v[48:51], v13 offset:14336
  s_waitcnt lgkmcnt(8)
  v_mfma_f32_16x16x32_bf16 v[184:187], v[36:39], v[104:107], v[184:187]
  ds_read_b128 v[100:103], v10 offset:29696
  v_mfma_f32_16x16x32_bf16 v[188:191], v[40:43], v[104:107], v[188:191]
  v_cvt_pk_bf16_f32 v72, v113, v129
  v_cvt_pk_bf16_f32 v73, v145, v161
  v_cvt_pk_bf16_f32 v74, v177, v193
  v_cvt_pk_bf16_f32 v75, v209, v225
  s_mov_b32 s36, 9216
  buffer_store_dwordx4 v[72:75], v6, s[28:31], s36 offen
  s_waitcnt lgkmcnt(8)
  v_mfma_f32_16x16x32_bf16 v[200:203], v[36:39], v[108:111], v[200:203]
  ds_read_b128 v[104:107], v10 offset:30720
  v_mfma_f32_16x16x32_bf16 v[204:207], v[40:43], v[108:111], v[204:207]
  s_waitcnt lgkmcnt(8)
  v_mfma_f32_16x16x32_bf16 v[216:219], v[36:39], v[80:83], v[216:219]
  ds_read_b128 v[108:111], v11 offset:31744
  v_mfma_f32_16x16x32_bf16 v[220:223], v[40:43], v[80:83], v[220:223]
  v_cvt_pk_bf16_f32 v76, v114, v130
  v_cvt_pk_bf16_f32 v77, v146, v162
  v_cvt_pk_bf16_f32 v78, v178, v194
  v_cvt_pk_bf16_f32 v79, v210, v226
  s_mov_b32 s36, 18432
  buffer_store_dwordx4 v[76:79], v6, s[28:31], s36 offen
  s_waitcnt lgkmcnt(8)
  v_mfma_f32_16x16x32_bf16 v[232:235], v[36:39], v[84:87], v[232:235]
  ds_read_b128 v[80:83], v11 offset:32768
  v_mfma_f32_16x16x32_bf16 v[236:239], v[40:43], v[84:87], v[236:239]
  s_waitcnt lgkmcnt(8)
  v_mfma_f32_16x16x32_bf16 v[248:251], v[88:91], v[36:39], v[248:251]
  ds_read_b128 v[84:87], v11 offset:33792
  v_mfma_f32_16x16x32_bf16 v[252:255], v[88:91], v[40:43], v[252:255]
  v_cvt_pk_bf16_f32 v68, v115, v131
  v_cvt_pk_bf16_f32 v69, v147, v163
  v_cvt_pk_bf16_f32 v70, v179, v195
  v_cvt_pk_bf16_f32 v71, v211, v227
  s_mov_b32 s36, 27648
  buffer_store_dwordx4 v[68:71], v6, s[28:31], s36 offen
  s_waitcnt lgkmcnt(5)
  v_mfma_f32_16x16x32_bf16 v[120:123], v[44:47], v[92:95], v[120:123]
  ds_read_b128 v[88:91], v11 offset:34816
  v_mfma_f32_16x16x32_bf16 v[124:127], v[48:51], v[92:95], v[124:127]
  s_waitcnt lgkmcnt(6)
  v_mfma_f32_16x16x32_bf16 v[136:139], v[44:47], v[96:99], v[136:139]
  ds_read_b128 v[92:95], v10 offset:35840
  v_mfma_f32_16x16x32_bf16 v[140:143], v[48:51], v[96:99], v[140:143]
  v_cvt_pk_bf16_f32 v72, v240, v241
  v_cvt_pk_bf16_f32 v73, v242, v243
  s_mov_b32 s36, 0
  buffer_store_dwordx2 v[72:73], v7, s[28:31], s36 offen offset:256
  s_waitcnt lgkmcnt(6)
  v_mfma_f32_16x16x32_bf16 v[152:155], v[44:47], v[100:103], v[152:155]
  ds_read_b128 v[96:99], v10 offset:36864
  v_mfma_f32_16x16x32_bf16 v[156:159], v[48:51], v[100:103], v[156:159]
  ds_read_b128 v[52:55], v12 offset:20480
  s_waitcnt lgkmcnt(7)
  v_mfma_f32_16x16x32_bf16 v[168:171], v[44:47], v[104:107], v[168:171]
  ds_read_b128 v[100:103], v10 offset:37888
  v_mfma_f32_16x16x32_bf16 v[172:175], v[48:51], v[104:107], v[172:175]
  ds_read_b128 v[56:59], v12 offset:22528
  v_cvt_pk_bf16_f32 v76, v116, v132
  v_cvt_pk_bf16_f32 v77, v148, v164
  v_cvt_pk_bf16_f32 v78, v180, v196
  v_cvt_pk_bf16_f32 v79, v212, v228
  s_mov_b32 s36, 147456
  buffer_store_dwordx4 v[76:79], v6, s[28:31], s36 offen
  s_waitcnt lgkmcnt(8)
  v_mfma_f32_16x16x32_bf16 v[184:187], v[44:47], v[108:111], v[184:187]
  ds_read_b128 v[104:107], v10 offset:38912
  v_mfma_f32_16x16x32_bf16 v[188:191], v[48:51], v[108:111], v[188:191]
  s_waitcnt lgkmcnt(8)
  v_mfma_f32_16x16x32_bf16 v[200:203], v[44:47], v[80:83], v[200:203]
  ds_read_b128 v[108:111], v10 offset:39936
  v_mfma_f32_16x16x32_bf16 v[204:207], v[48:51], v[80:83], v[204:207]
  v_cvt_pk_bf16_f32 v68, v117, v133
  v_cvt_pk_bf16_f32 v69, v149, v165
  v_cvt_pk_bf16_f32 v70, v181, v197
  v_cvt_pk_bf16_f32 v71, v213, v229
  s_mov_b32 s36, 156672
  buffer_store_dwordx4 v[68:71], v6, s[28:31], s36 offen
  s_waitcnt lgkmcnt(8)
  v_mfma_f32_16x16x32_bf16 v[216:219], v[44:47], v[84:87], v[216:219]
  ds_read_b128 v[80:83], v11 offset:40960
  v_mfma_f32_16x16x32_bf16 v[220:223], v[48:51], v[84:87], v[220:223]
  s_waitcnt lgkmcnt(8)
  v_mfma_f32_16x16x32_bf16 v[232:235], v[44:47], v[88:91], v[232:235]
  ds_read_b128 v[84:87], v11 offset:41984
  v_mfma_f32_16x16x32_bf16 v[236:239], v[48:51], v[88:91], v[236:239]
  v_cvt_pk_bf16_f32 v72, v118, v134
  v_cvt_pk_bf16_f32 v73, v150, v166
  v_cvt_pk_bf16_f32 v74, v182, v198
  v_cvt_pk_bf16_f32 v75, v214, v230
  s_mov_b32 s36, 165888
  buffer_store_dwordx4 v[72:75], v6, s[28:31], s36 offen
  s_waitcnt lgkmcnt(8)
  v_mfma_f32_16x16x32_bf16 v[248:251], v[92:95], v[44:47], v[248:251]
  ds_read_b128 v[88:91], v11 offset:43008
  v_mfma_f32_16x16x32_bf16 v[252:255], v[92:95], v[48:51], v[252:255]
  s_waitcnt lgkmcnt(5)
  v_mfma_f32_16x16x32_bf16 v[120:123], v[52:55], v[96:99], v[120:123]
  ds_read_b128 v[92:95], v11 offset:44032
  v_mfma_f32_16x16x32_bf16 v[124:127], v[56:59], v[96:99], v[124:127]
  v_cvt_pk_bf16_f32 v76, v119, v135
  v_cvt_pk_bf16_f32 v77, v151, v167
  v_cvt_pk_bf16_f32 v78, v183, v199
  v_cvt_pk_bf16_f32 v79, v215, v231
  s_mov_b32 s36, 175104
  buffer_store_dwordx4 v[76:79], v6, s[28:31], s36 offen
  s_waitcnt lgkmcnt(6)
  v_mfma_f32_16x16x32_bf16 v[136:139], v[52:55], v[100:103], v[136:139]
  ds_read_b128 v[96:99], v10 offset:45056
  v_mfma_f32_16x16x32_bf16 v[140:143], v[56:59], v[100:103], v[140:143]
  s_waitcnt lgkmcnt(6)
  v_mfma_f32_16x16x32_bf16 v[152:155], v[52:55], v[104:107], v[152:155]
  ds_read_b128 v[100:103], v10 offset:46080
  v_mfma_f32_16x16x32_bf16 v[156:159], v[56:59], v[104:107], v[156:159]
  ds_read_b128 v[60:63], v13 offset:20480
  v_cvt_pk_bf16_f32 v68, v244, v245
  v_cvt_pk_bf16_f32 v69, v246, v247
  s_mov_b32 s36, 147456
  buffer_store_dwordx2 v[68:69], v7, s[28:31], s36 offen offset:256
  s_waitcnt lgkmcnt(7)
  v_mfma_f32_16x16x32_bf16 v[168:171], v[52:55], v[108:111], v[168:171]
  ds_read_b128 v[104:107], v10 offset:47104
  v_mfma_f32_16x16x32_bf16 v[172:175], v[56:59], v[108:111], v[172:175]
  ds_read_b128 v[64:67], v13 offset:22528
  s_waitcnt lgkmcnt(8)
  v_mfma_f32_16x16x32_bf16 v[184:187], v[52:55], v[80:83], v[184:187]
  ds_read_b128 v[108:111], v10 offset:48128
  v_mfma_f32_16x16x32_bf16 v[188:191], v[56:59], v[80:83], v[188:191]
  s_waitcnt lgkmcnt(8)
  v_mfma_f32_16x16x32_bf16 v[200:203], v[52:55], v[84:87], v[200:203]
  ds_read_b128 v[80:83], v10 offset:49152
  v_mfma_f32_16x16x32_bf16 v[204:207], v[56:59], v[84:87], v[204:207]
  s_waitcnt lgkmcnt(8)
  v_mfma_f32_16x16x32_bf16 v[216:219], v[52:55], v[88:91], v[216:219]
  ds_read_b128 v[84:87], v11 offset:50176
  v_mfma_f32_16x16x32_bf16 v[220:223], v[56:59], v[88:91], v[220:223]
  s_waitcnt lgkmcnt(8)
  v_mfma_f32_16x16x32_bf16 v[232:235], v[52:55], v[92:95], v[232:235]
  ds_read_b128 v[88:91], v11 offset:51200
  v_mfma_f32_16x16x32_bf16 v[236:239], v[56:59], v[92:95], v[236:239]
  s_waitcnt lgkmcnt(8)
  v_mfma_f32_16x16x32_bf16 v[248:251], v[96:99], v[52:55], v[248:251]
  ds_read_b128 v[92:95], v11 offset:52224
  v_mfma_f32_16x16x32_bf16 v[252:255], v[96:99], v[56:59], v[252:255]
  s_waitcnt lgkmcnt(5)
  v_mfma_f32_16x16x32_bf16 v[120:123], v[60:63], v[100:103], v[120:123]
  ds_read_b128 v[96:99], v11 offset:53248
  v_mfma_f32_16x16x32_bf16 v[124:127], v[64:67], v[100:103], v[124:127]
  s_waitcnt lgkmcnt(6)
  v_mfma_f32_16x16x32_bf16 v[136:139], v[60:63], v[104:107], v[136:139]
  ds_read_b128 v[100:103], v10 offset:54272
  v_mfma_f32_16x16x32_bf16 v[140:143], v[64:67], v[104:107], v[140:143]
  s_waitcnt lgkmcnt(6)
  v_mfma_f32_16x16x32_bf16 v[152:155], v[60:63], v[108:111], v[152:155]
  v_mfma_f32_16x16x32_bf16 v[156:159], v[64:67], v[108:111], v[156:159]
  s_waitcnt lgkmcnt(5)
  v_mfma_f32_16x16x32_bf16 v[168:171], v[60:63], v[80:83], v[168:171]
  v_mfma_f32_16x16x32_bf16 v[172:175], v[64:67], v[80:83], v[172:175]
  s_waitcnt lgkmcnt(4)
  v_mfma_f32_16x16x32_bf16 v[184:187], v[60:63], v[84:87], v[184:187]
  v_mfma_f32_16x16x32_bf16 v[188:191], v[64:67], v[84:87], v[188:191]
  s_waitcnt lgkmcnt(3)
  v_mfma_f32_16x16x32_bf16 v[200:203], v[60:63], v[88:91], v[200:203]
  v_mfma_f32_16x16x32_bf16 v[204:207], v[64:67], v[88:91], v[204:207]
  s_waitcnt lgkmcnt(2)
  v_mfma_f32_16x16x32_bf16 v[216:219], v[60:63], v[92:95], v[216:219]
  v_mfma_f32_16x16x32_bf16 v[220:223], v[64:67], v[92:95], v[220:223]
  s_waitcnt lgkmcnt(1)
  v_mfma_f32_16x16x32_bf16 v[232:235], v[60:63], v[96:99], v[232:235]
  v_mfma_f32_16x16x32_bf16 v[236:239], v[64:67], v[96:99], v[236:239]
  s_waitcnt lgkmcnt(0)
  v_mfma_f32_16x16x32_bf16 v[248:251], v[100:103], v[60:63], v[248:251]
  v_mfma_f32_16x16x32_bf16 v[252:255], v[100:103], v[64:67], v[252:255]
  s_nop 7
  s_nop 7
  s_nop 3
  v_cvt_pk_bf16_f32 v20, v120, v136
  v_cvt_pk_bf16_f32 v21, v152, v168
  v_cvt_pk_bf16_f32 v22, v184, v200
  v_cvt_pk_bf16_f32 v23, v216, v232
  s_mov_b32 s36, 294912
  buffer_store_dwordx4 v[20:23], v6, s[28:31], s36 offen
  v_cvt_pk_bf16_f32 v24, v121, v137
  v_cvt_pk_bf16_f32 v25, v153, v169
  v_cvt_pk_bf16_f32 v26, v185, v201
  v_cvt_pk_bf16_f32 v27, v217, v233
  s_mov_b32 s36, 304128
  buffer_store_dwordx4 v[24:27], v6, s[28:31], s36 offen
  v_cvt_pk_bf16_f32 v28, v122, v138
  v_cvt_pk_bf16_f32 v29, v154, v170
  v_cvt_pk_bf16_f32 v30, v186, v202
  v_cvt_pk_bf16_f32 v31, v218, v234
  s_mov_b32 s36, 313344
  buffer_store_dwordx4 v[28:31], v6, s[28:31], s36 offen
  v_cvt_pk_bf16_f32 v32, v123, v139
  v_cvt_pk_bf16_f32 v33, v155, v171
  v_cvt_pk_bf16_f32 v34, v187, v203
  v_cvt_pk_bf16_f32 v35, v219, v235
  s_mov_b32 s36, 322560
  buffer_store_dwordx4 v[32:35], v6, s[28:31], s36 offen
  v_cvt_pk_bf16_f32 v36, v248, v249
  v_cvt_pk_bf16_f32 v37, v250, v251
  s_mov_b32 s36, 294912
  buffer_store_dwordx2 v[36:37], v7, s[28:31], s36 offen offset:256
  v_cvt_pk_bf16_f32 v40, v124, v140
  v_cvt_pk_bf16_f32 v41, v156, v172
  v_cvt_pk_bf16_f32 v42, v188, v204
  v_cvt_pk_bf16_f32 v43, v220, v236
  s_mov_b32 s36, 442368
  buffer_store_dwordx4 v[40:43], v6, s[28:31], s36 offen
  v_cvt_pk_bf16_f32 v44, v125, v141
  v_cvt_pk_bf16_f32 v45, v157, v173
  v_cvt_pk_bf16_f32 v46, v189, v205
  v_cvt_pk_bf16_f32 v47, v221, v237
  s_mov_b32 s36, 451584
  buffer_store_dwordx4 v[44:47], v6, s[28:31], s36 offen
  v_cvt_pk_bf16_f32 v48, v126, v142
  v_cvt_pk_bf16_f32 v49, v158, v174
  v_cvt_pk_bf16_f32 v50, v190, v206
  v_cvt_pk_bf16_f32 v51, v222, v238
  s_mov_b32 s36, 460800
  buffer_store_dwordx4 v[48:51], v6, s[28:31], s36 offen
  v_cvt_pk_bf16_f32 v52, v127, v143
  v_cvt_pk_bf16_f32 v53, v159, v175
  v_cvt_pk_bf16_f32 v54, v191, v207
  v_cvt_pk_bf16_f32 v55, v223, v239
  s_mov_b32 s36, 470016
  buffer_store_dwordx4 v[52:55], v6, s[28:31], s36 offen
  v_cvt_pk_bf16_f32 v56, v252, v253
  v_cvt_pk_bf16_f32 v57, v254, v255
  s_mov_b32 s36, 442368
  buffer_store_dwordx2 v[56:57], v7, s[28:31], s36 offen offset:256
  s_endpgm
L_producer:
  s_sub_u32 s3, s3, 4
  v_lshrrev_b32 v5, 5, v2
  v_and_b32 v6, 31, v2
  s_lshl_b32 s32, s3, 1
  v_add_u32 v7, s32, v5
  s_mov_b32 s34, 147456
  v_mul_lo_u32 v8, v7, s34
  s_lshl_b32 s33, s14, 2
  v_lshl_add_u32 v8, v6, 4, v8
  v_add_u32 v8, s33, v8
  v_lshrrev_b32 v9, 2, v2
  s_lshl_b32 s35, s3, 4
  v_add_u32 v9, s35, v9
  s_movk_i32 s34, 18432
  v_mul_lo_u32 v10, v9, s34
  v_and_b32 v11, 3, v2
  v_lshl_add_u32 v10, v11, 4, v10
  v_add_u32 v10, s33, v10
  s_mov_b32 s48, 0
  s_mov_b32 s49, 18432
  s_mov_b32 s50, 36864
  s_mov_b32 s51, 55296
  s_mov_b32 s52, 73728
  s_mov_b32 s53, 92160
  s_mov_b32 s54, 110592
  s_mov_b32 s55, 129024
  buffer_load_dwordx4 v[20:23], v8, s[20:23], s48 offen
  buffer_load_dwordx4 v[24:27], v8, s[20:23], s49 offen
  buffer_load_dwordx4 v[28:31], v8, s[20:23], s50 offen
  buffer_load_dwordx4 v[32:35], v8, s[20:23], s51 offen
  buffer_load_dwordx4 v[36:39], v8, s[20:23], s52 offen
  buffer_load_dwordx4 v[40:43], v8, s[20:23], s53 offen
  buffer_load_dwordx4 v[44:47], v8, s[20:23], s54 offen
  buffer_load_dwordx4 v[48:51], v8, s[20:23], s55 offen
  buffer_load_dwordx4 v[52:55], v10, s[20:23], 0 offen offset:512
  v_add_u32 v8, 1179648, v8
  v_add_u32 v10, 1179648, v10
  v_lshlrev_b32 v12, 2, v6
  v_and_b32 v1, 1, v6
  v_lshrrev_b32 v13, 1, v6
  v_lshlrev_b32 v16, 2, v1
  v_xor_b32 v13, v13, v16
  v_lshlrev_b32 v13, 4, v13
  v_lshl_add_u32 v13, v1, 12, v13
  v_lshrrev_b32 v1, 2, v7
  s_movk_i32 s34, 9216
  v_mul_lo_u32 v1, v1, s34
  v_add_u32 v13, v13, v1
  v_and_b32 v1, 3, v7
  v_lshl_add_u32 v13, v1, 8, v13
  v_add_u32 v16, 8192, v13
  v_lshrrev_b32 v1, 5, v9
  v_mul_lo_u32 v1, v1, s34
  v_add_u32 v13, 16384, v1
  v_bfe_u32 v1, v9, 3, 2
  v_lshl_add_u32 v13, v1, 8, v13
  v_lshl_add_u32 v13, v11, 6, v13
  v_and_b32 v1, 7, v9
  v_lshl_add_u32 v17, v1, 1, v13
  s_barrier
  s_waitcnt vmcnt(0)
  v_lshl_add_u32 v20, v20, 7, v12
  v_lshl_add_u32 v24, v24, 7, v12
  v_lshl_add_u32 v28, v28, 7, v12
  ds_read_u16 v128, v20 offset:0
  buffer_load_dwordx4 v[56:59], v8, s[20:23], s48 offen
  v_lshl_add_u32 v32, v32, 7, v12
  ds_read_u16 v129, v24 offset:0
  v_lshl_add_u32 v36, v36, 7, v12
  ds_read_u16 v130, v28 offset:0
  v_lshl_add_u32 v40, v40, 7, v12
  ds_read_u16 v131, v32 offset:0
  buffer_load_dwordx4 v[60:63], v8, s[20:23], s49 offen
  v_lshl_add_u32 v44, v44, 7, v12
  ds_read_u16 v132, v36 offset:0
  v_lshl_add_u32 v48, v48, 7, v12
  ds_read_u16 v133, v40 offset:0
  v_lshl_add_u32 v52, v52, 7, v12
  ds_read_u16 v134, v44 offset:0
  buffer_load_dwordx4 v[64:67], v8, s[20:23], s50 offen
  ds_read_u16 v135, v48 offset:0
  ds_read_u16 v136, v52 offset:4096
  v_lshl_add_u32 v21, v21, 7, v12
  v_lshl_add_u32 v25, v25, 7, v12
  v_lshl_add_u32 v29, v29, 7, v12
  ds_read_u16 v137, v21 offset:2
  buffer_load_dwordx4 v[68:71], v8, s[20:23], s51 offen
  v_lshl_add_u32 v33, v33, 7, v12
  ds_read_u16 v138, v25 offset:2
  v_lshl_add_u32 v37, v37, 7, v12
  ds_read_u16 v139, v29 offset:2
  v_lshl_add_u32 v41, v41, 7, v12
  ds_read_u16 v140, v33 offset:2
  buffer_load_dwordx4 v[72:75], v8, s[20:23], s52 offen
  v_lshl_add_u32 v45, v45, 7, v12
  ds_read_u16 v141, v37 offset:2
  v_lshl_add_u32 v49, v49, 7, v12
  ds_read_u16 v142, v41 offset:2
  v_lshl_add_u32 v53, v53, 7, v12
  ds_read_u16 v143, v45 offset:2
  buffer_load_dwordx4 v[76:79], v8, s[20:23], s53 offen
  ds_read_u16 v144, v49 offset:2
  ds_read_u16 v145, v53 offset:4098
  v_lshl_add_u32 v22, v22, 7, v12
  v_lshl_add_u32 v26, v26, 7, v12
  v_lshl_add_u32 v30, v30, 7, v12
  ds_read_u16 v146, v22 offset:2048
  buffer_load_dwordx4 v[80:83], v8, s[20:23], s54 offen
  v_lshl_add_u32 v34, v34, 7, v12
  ds_read_u16 v147, v26 offset:2048
  v_lshl_add_u32 v38, v38, 7, v12
  ds_read_u16 v148, v30 offset:2048
  v_lshl_add_u32 v42, v42, 7, v12
  ds_read_u16 v149, v34 offset:2048
  buffer_load_dwordx4 v[84:87], v8, s[20:23], s55 offen
  v_lshl_add_u32 v46, v46, 7, v12
  ds_read_u16 v150, v38 offset:2048
  v_lshl_add_u32 v50, v50, 7, v12
  ds_read_u16 v151, v42 offset:2048
  v_lshl_add_u32 v54, v54, 7, v12
  ds_read_u16 v152, v46 offset:2048
  buffer_load_dwordx4 v[88:91], v10, s[20:23], 0 offen offset:512
  v_add_u32 v8, 1179648, v8
  v_add_u32 v10, 1179648, v10
  ds_read_u16 v153, v50 offset:2048
  ds_read_u16 v154, v54 offset:6144
  v_lshl_add_u32 v23, v23, 7, v12
  v_lshl_add_u32 v27, v27, 7, v12
  v_lshl_add_u32 v31, v31, 7, v12
  ds_read_u16 v155, v23 offset:2050
  buffer_load_dwordx4 v[92:95], v8, s[20:23], s48 offen
  v_lshl_add_u32 v35, v35, 7, v12
  ds_read_u16 v156, v27 offset:2050
  v_lshl_add_u32 v39, v39, 7, v12
  ds_read_u16 v157, v31 offset:2050
  v_lshl_add_u32 v43, v43, 7, v12
  ds_read_u16 v158, v35 offset:2050
  buffer_load_dwordx4 v[96:99], v8, s[20:23], s49 offen
  v_lshl_add_u32 v47, v47, 7, v12
  ds_read_u16 v159, v39 offset:2050
  v_lshl_add_u32 v51, v51, 7, v12
  ds_read_u16 v160, v43 offset:2050
  v_lshl_add_u32 v55, v55, 7, v12
  ds_read_u16 v161, v47 offset:2050
  buffer_load_dwordx4 v[100:103], v8, s[20:23], s50 offen
  ds_read_u16 v162, v51 offset:2050
  ds_read_u16 v163, v55 offset:6146
  s_waitcnt lgkmcnt(15)
  v_lshl_or_b32 v164, v129, 16, v128
  v_lshl_or_b32 v165, v131, 16, v130
  v_lshl_or_b32 v166, v133, 16, v132
  v_lshl_or_b32 v167, v135, 16, v134
  ds_write_b128 v16, v[164:167] offset:0
  ds_write_b16 v17, v136 offset:0
  s_waitcnt lgkmcnt(15)
  v_lshl_or_b32 v168, v138, 16, v137
  v_lshl_or_b32 v169, v140, 16, v139
  v_lshl_or_b32 v170, v142, 16, v141
  v_lshl_or_b32 v171, v144, 16, v143
  ds_write_b128 v16, v[168:171] offset:1024
  ds_write_b16 v17, v145 offset:16
  s_waitcnt lgkmcnt(13)
  v_lshl_or_b32 v172, v147, 16, v146
  v_lshl_or_b32 v173, v149, 16, v148
  v_lshl_or_b32 v174, v151, 16, v150
  v_lshl_or_b32 v175, v153, 16, v152
  ds_write_b128 v16, v[172:175] offset:2048
  ds_write_b16 v17, v154 offset:32
  s_waitcnt lgkmcnt(6)
  v_lshl_or_b32 v176, v156, 16, v155
  v_lshl_or_b32 v177, v158, 16, v157
  v_lshl_or_b32 v178, v160, 16, v159
  v_lshl_or_b32 v179, v162, 16, v161
  ds_write_b128 v16, v[176:179] offset:3072
  ds_write_b16 v17, v163 offset:48
  s_waitcnt lgkmcnt(0)
  s_barrier
  s_waitcnt vmcnt(3)
  v_lshl_add_u32 v56, v56, 7, v12
  v_lshl_add_u32 v60, v60, 7, v12
  buffer_load_dwordx4 v[104:107], v8, s[20:23], s51 offen
  v_lshl_add_u32 v64, v64, 7, v12
  ds_read_u16 v128, v56 offset:0
  v_lshl_add_u32 v68, v68, 7, v12
  ds_read_u16 v129, v60 offset:0
  v_lshl_add_u32 v72, v72, 7, v12
  ds_read_u16 v130, v64 offset:0
  buffer_load_dwordx4 v[108:111], v8, s[20:23], s52 offen
  v_lshl_add_u32 v76, v76, 7, v12
  ds_read_u16 v131, v68 offset:0
  v_lshl_add_u32 v80, v80, 7, v12
  ds_read_u16 v132, v72 offset:0
  v_lshl_add_u32 v84, v84, 7, v12
  ds_read_u16 v133, v76 offset:0
  buffer_load_dwordx4 v[112:115], v8, s[20:23], s53 offen
  v_lshl_add_u32 v88, v88, 7, v12
  ds_read_u16 v134, v80 offset:0
  ds_read_u16 v135, v84 offset:0
  buffer_load_dwordx4 v[116:119], v8, s[20:23], s54 offen
  ds_read_u16 v136, v88 offset:4096
  v_lshl_add_u32 v57, v57, 7, v12
  v_lshl_add_u32 v61, v61, 7, v12
  buffer_load_dwordx4 v[120:123], v8, s[20:23], s55 offen
  v_lshl_add_u32 v65, v65, 7, v12
  ds_read_u16 v137, v57 offset:2
  v_lshl_add_u32 v69, v69, 7, v12
  ds_read_u16 v138, v61 offset:2
  v_lshl_add_u32 v73, v73, 7, v12
  ds_read_u16 v139, v65 offset:2
  buffer_load_dwordx4 v[124:127], v10, s[20:23], 0 offen offset:512
  v_add_u32 v8, 1179648, v8
  v_add_u32 v10, 1179648, v10
  v_lshl_add_u32 v77, v77, 7, v12
  ds_read_u16 v140, v69 offset:2
  v_lshl_add_u32 v81, v81, 7, v12
  ds_read_u16 v141, v73 offset:2
  v_lshl_add_u32 v85, v85, 7, v12
  ds_read_u16 v142, v77 offset:2
  buffer_load_dwordx4 v[20:23], v8, s[20:23], s48 offen
  v_lshl_add_u32 v89, v89, 7, v12
  ds_read_u16 v143, v81 offset:2
  ds_read_u16 v144, v85 offset:2
  buffer_load_dwordx4 v[24:27], v8, s[20:23], s49 offen
  ds_read_u16 v145, v89 offset:4098
  v_lshl_add_u32 v58, v58, 7, v12
  v_lshl_add_u32 v62, v62, 7, v12
  buffer_load_dwordx4 v[28:31], v8, s[20:23], s50 offen
  v_lshl_add_u32 v66, v66, 7, v12
  ds_read_u16 v146, v58 offset:2048
  v_lshl_add_u32 v70, v70, 7, v12
  ds_read_u16 v147, v62 offset:2048
  v_lshl_add_u32 v74, v74, 7, v12
  ds_read_u16 v148, v66 offset:2048
  buffer_load_dwordx4 v[32:35], v8, s[20:23], s51 offen
  v_lshl_add_u32 v78, v78, 7, v12
  ds_read_u16 v149, v70 offset:2048
  v_lshl_add_u32 v82, v82, 7, v12
  ds_read_u16 v150, v74 offset:2048
  v_lshl_add_u32 v86, v86, 7, v12
  ds_read_u16 v151, v78 offset:2048
  buffer_load_dwordx4 v[36:39], v8, s[20:23], s52 offen
  v_lshl_add_u32 v90, v90, 7, v12
  ds_read_u16 v152, v82 offset:2048
  ds_read_u16 v153, v86 offset:2048
  buffer_load_dwordx4 v[40:43], v8, s[20:23], s53 offen
  ds_read_u16 v154, v90 offset:6144
  v_lshl_add_u32 v59, v59, 7, v12
  v_lshl_add_u32 v63, v63, 7, v12
  buffer_load_dwordx4 v[44:47], v8, s[20:23], s54 offen
  v_lshl_add_u32 v67, v67, 7, v12
  ds_read_u16 v155, v59 offset:2050
  v_lshl_add_u32 v71, v71, 7, v12
  ds_read_u16 v156, v63 offset:2050
  v_lshl_add_u32 v75, v75, 7, v12
  ds_read_u16 v157, v67 offset:2050
  buffer_load_dwordx4 v[48:51], v8, s[20:23], s55 offen
  v_lshl_add_u32 v79, v79, 7, v12
  ds_read_u16 v158, v71 offset:2050
  v_lshl_add_u32 v83, v83, 7, v12
  ds_read_u16 v159, v75 offset:2050
  v_lshl_add_u32 v87, v87, 7, v12
  ds_read_u16 v160, v79 offset:2050
  buffer_load_dwordx4 v[52:55], v10, s[20:23], 0 offen offset:512
  v_add_u32 v8, 1179648, v8
  v_add_u32 v10, 1179648, v10
  v_lshl_add_u32 v91, v91, 7, v12
  ds_read_u16 v161, v83 offset:2050
  ds_read_u16 v162, v87 offset:2050
  ds_read_u16 v163, v91 offset:6146
  s_waitcnt lgkmcnt(15)
  v_lshl_or_b32 v164, v129, 16, v128
  v_lshl_or_b32 v165, v131, 16, v130
  v_lshl_or_b32 v166, v133, 16, v132
  v_lshl_or_b32 v167, v135, 16, v134
  ds_write_b128 v16, v[164:167] offset:18432
  ds_write_b16 v17, v136 offset:18432
  s_waitcnt lgkmcnt(15)
  v_lshl_or_b32 v168, v138, 16, v137
  v_lshl_or_b32 v169, v140, 16, v139
  v_lshl_or_b32 v170, v142, 16, v141
  v_lshl_or_b32 v171, v144, 16, v143
  ds_write_b128 v16, v[168:171] offset:19456
  ds_write_b16 v17, v145 offset:18448
  s_waitcnt lgkmcnt(13)
  v_lshl_or_b32 v172, v147, 16, v146
  v_lshl_or_b32 v173, v149, 16, v148
  v_lshl_or_b32 v174, v151, 16, v150
  v_lshl_or_b32 v175, v153, 16, v152
  ds_write_b128 v16, v[172:175] offset:20480
  ds_write_b16 v17, v154 offset:18464
  s_waitcnt lgkmcnt(6)
  v_lshl_or_b32 v176, v156, 16, v155
  v_lshl_or_b32 v177, v158, 16, v157
  v_lshl_or_b32 v178, v160, 16, v159
  v_lshl_or_b32 v179, v162, 16, v161
  ds_write_b128 v16, v[176:179] offset:21504
  ds_write_b16 v17, v163 offset:18480
  s_waitcnt vmcnt(9)
  v_lshl_add_u32 v92, v92, 7, v12
  v_lshl_add_u32 v96, v96, 7, v12
  v_lshl_add_u32 v100, v100, 7, v12
  ds_read_u16 v128, v92 offset:0
  v_lshl_add_u32 v104, v104, 7, v12
  ds_read_u16 v129, v96 offset:0
  buffer_load_dwordx4 v[56:59], v8, s[20:23], s48 offen
  v_lshl_add_u32 v108, v108, 7, v12
  ds_read_u16 v130, v100 offset:0
  v_lshl_add_u32 v112, v112, 7, v12
  ds_read_u16 v131, v104 offset:0
  v_lshl_add_u32 v116, v116, 7, v12
  ds_read_u16 v132, v108 offset:0
  v_lshl_add_u32 v120, v120, 7, v12
  ds_read_u16 v133, v112 offset:0
  buffer_load_dwordx4 v[60:63], v8, s[20:23], s49 offen
  v_lshl_add_u32 v124, v124, 7, v12
  ds_read_u16 v134, v116 offset:0
  ds_read_u16 v135, v120 offset:0
  ds_read_u16 v136, v124 offset:4096
  v_lshl_add_u32 v93, v93, 7, v12
  v_lshl_add_u32 v97, v97, 7, v12
  v_lshl_add_u32 v101, v101, 7, v12
  ds_read_u16 v137, v93 offset:2
  v_lshl_add_u32 v105, v105, 7, v12
  ds_read_u16 v138, v97 offset:2
  buffer_load_dwordx4 v[64:67], v8, s[20:23], s50 offen
  v_lshl_add_u32 v109, v109, 7, v12
  ds_read_u16 v139, v101 offset:2
  v_lshl_add_u32 v113, v113, 7, v12
  ds_read_u16 v140, v105 offset:2
  v_lshl_add_u32 v117, v117, 7, v12
  ds_read_u16 v141, v109 offset:2
  v_lshl_add_u32 v121, v121, 7, v12
  ds_read_u16 v142, v113 offset:2
  buffer_load_dwordx4 v[68:71], v8, s[20:23], s51 offen
  v_lshl_add_u32 v125, v125, 7, v12
  ds_read_u16 v143, v117 offset:2
  ds_read_u16 v144, v121 offset:2
  ds_read_u16 v145, v125 offset:4098
  s_waitcnt lgkmcnt(15)
  s_barrier
  v_lshl_add_u32 v94, v94, 7, v12
  v_lshl_add_u32 v98, v98, 7, v12
  v_lshl_add_u32 v102, v102, 7, v12
  ds_read_u16 v146, v94 offset:2048
  v_lshl_add_u32 v106, v106, 7, v12
  ds_read_u16 v147, v98 offset:2048
  buffer_load_dwordx4 v[72:75], v8, s[20:23], s52 offen
  v_lshl_add_u32 v110, v110, 7, v12
  ds_read_u16 v148, v102 offset:2048
  v_lshl_add_u32 v114, v114, 7, v12
  ds_read_u16 v149, v106 offset:2048
  v_lshl_add_u32 v118, v118, 7, v12
  ds_read_u16 v150, v110 offset:2048
  v_lshl_add_u32 v122, v122, 7, v12
  ds_read_u16 v151, v114 offset:2048
  buffer_load_dwordx4 v[76:79], v8, s[20:23], s53 offen
  v_lshl_add_u32 v126, v126, 7, v12
  ds_read_u16 v152, v118 offset:2048
  ds_read_u16 v153, v122 offset:2048
  ds_read_u16 v154, v126 offset:6144
  v_lshl_add_u32 v95, v95, 7, v12
  v_lshl_add_u32 v99, v99, 7, v12
  v_lshl_add_u32 v103, v103, 7, v12
  ds_read_u16 v155, v95 offset:2050
  v_lshl_add_u32 v107, v107, 7, v12
  ds_read_u16 v156, v99 offset:2050
  buffer_load_dwordx4 v[80:83], v8, s[20:23], s54 offen
  v_lshl_add_u32 v111, v111, 7, v12
  ds_read_u16 v157, v103 offset:2050
  v_lshl_add_u32 v115, v115, 7, v12
  ds_read_u16 v158, v107 offset:2050
  v_lshl_add_u32 v119, v119, 7, v12
  ds_read_u16 v159, v111 offset:2050
  v_lshl_add_u32 v123, v123, 7, v12
  ds_read_u16 v160, v115 offset:2050
  buffer_load_dwordx4 v[84:87], v8, s[20:23], s55 offen
  v_lshl_add_u32 v127, v127, 7, v12
  ds_read_u16 v161, v119 offset:2050
  ds_read_u16 v162, v123 offset:2050
  ds_read_u16 v163, v127 offset:6146
  buffer_load_dwordx4 v[88:91], v10, s[20:23], 0 offen offset:512
  v_add_u32 v8, 1179648, v8
  v_add_u32 v10, 1179648, v10
  s_waitcnt lgkmcnt(15)
  v_lshl_or_b32 v164, v129, 16, v128
  v_lshl_or_b32 v165, v131, 16, v130
  v_lshl_or_b32 v166, v133, 16, v132
  v_lshl_or_b32 v167, v135, 16, v134
  ds_write_b128 v16, v[164:167] offset:36864
  ds_write_b16 v17, v136 offset:36864
  s_waitcnt lgkmcnt(15)
  v_lshl_or_b32 v168, v138, 16, v137
  v_lshl_or_b32 v169, v140, 16, v139
  v_lshl_or_b32 v170, v142, 16, v141
  v_lshl_or_b32 v171, v144, 16, v143
  ds_write_b128 v16, v[168:171] offset:37888
  ds_write_b16 v17, v145 offset:36880
  s_waitcnt lgkmcnt(13)
  v_lshl_or_b32 v172, v147, 16, v146
  v_lshl_or_b32 v173, v149, 16, v148
  v_lshl_or_b32 v174, v151, 16, v150
  v_lshl_or_b32 v175, v153, 16, v152
  ds_write_b128 v16, v[172:175] offset:38912
  ds_write_b16 v17, v154 offset:36896
  s_waitcnt lgkmcnt(6)
  v_lshl_or_b32 v176, v156, 16, v155
  v_lshl_or_b32 v177, v158, 16, v157
  v_lshl_or_b32 v178, v160, 16, v159
  v_lshl_or_b32 v179, v162, 16, v161
  ds_write_b128 v16, v[176:179] offset:39936
  ds_write_b16 v17, v163 offset:36912
  s_waitcnt vmcnt(9)
  v_lshl_add_u32 v20, v20, 7, v12
  v_lshl_add_u32 v24, v24, 7, v12
  v_lshl_add_u32 v28, v28, 7, v12
  ds_read_u16 v128, v20 offset:0
  v_lshl_add_u32 v32, v32, 7, v12
  ds_read_u16 v129, v24 offset:0
  buffer_load_dwordx4 v[92:95], v8, s[20:23], s48 offen
  v_lshl_add_u32 v36, v36, 7, v12
  ds_read_u16 v130, v28 offset:0
  v_lshl_add_u32 v40, v40, 7, v12
  ds_read_u16 v131, v32 offset:0
  v_lshl_add_u32 v44, v44, 7, v12
  ds_read_u16 v132, v36 offset:0
  v_lshl_add_u32 v48, v48, 7, v12
  ds_read_u16 v133, v40 offset:0
  buffer_load_dwordx4 v[96:99], v8, s[20:23], s49 offen
  v_lshl_add_u32 v52, v52, 7, v12
  ds_read_u16 v134, v44 offset:0
  ds_read_u16 v135, v48 offset:0
  ds_read_u16 v136, v52 offset:4096
  v_lshl_add_u32 v21, v21, 7, v12
  v_lshl_add_u32 v25, v25, 7, v12
  v_lshl_add_u32 v29, v29, 7, v12
  ds_read_u16 v137, v21 offset:2
  v_lshl_add_u32 v33, v33, 7, v12
  ds_read_u16 v138, v25 offset:2
  buffer_load_dwordx4 v[100:103], v8, s[20:23], s50 offen
  v_lshl_add_u32 v37, v37, 7, v12
  ds_read_u16 v139, v29 offset:2
  v_lshl_add_u32 v41, v41, 7, v12
  ds_read_u16 v140, v33 offset:2
  v_lshl_add_u32 v45, v45, 7, v12
  ds_read_u16 v141, v37 offset:2
  v_lshl_add_u32 v49, v49, 7, v12
  ds_read_u16 v142, v41 offset:2
  buffer_load_dwordx4 v[104:107], v8, s[20:23], s51 offen
  v_lshl_add_u32 v53, v53, 7, v12
  ds_read_u16 v143, v45 offset:2
  ds_read_u16 v144, v49 offset:2
  ds_read_u16 v145, v53 offset:4098
  s_waitcnt lgkmcnt(15)
  s_barrier
  v_lshl_add_u32 v22, v22, 7, v12
  v_lshl_add_u32 v26, v26, 7, v12
  v_lshl_add_u32 v30, v30, 7, v12
  ds_read_u16 v146, v22 offset:2048
  v_lshl_add_u32 v34, v34, 7, v12
  ds_read_u16 v147, v26 offset:2048
  buffer_load_dwordx4 v[108:111], v8, s[20:23], s52 offen
  v_lshl_add_u32 v38, v38, 7, v12
  ds_read_u16 v148, v30 offset:2048
  v_lshl_add_u32 v42, v42, 7, v12
  ds_read_u16 v149, v34 offset:2048
  v_lshl_add_u32 v46, v46, 7, v12
  ds_read_u16 v150, v38 offset:2048
  v_lshl_add_u32 v50, v50, 7, v12
  ds_read_u16 v151, v42 offset:2048
  buffer_load_dwordx4 v[112:115], v8, s[20:23], s53 offen
  v_lshl_add_u32 v54, v54, 7, v12
  ds_read_u16 v152, v46 offset:2048
  ds_read_u16 v153, v50 offset:2048
  ds_read_u16 v154, v54 offset:6144
  v_lshl_add_u32 v23, v23, 7, v12
  v_lshl_add_u32 v27, v27, 7, v12
  v_lshl_add_u32 v31, v31, 7, v12
  ds_read_u16 v155, v23 offset:2050
  v_lshl_add_u32 v35, v35, 7, v12
  ds_read_u16 v156, v27 offset:2050
  buffer_load_dwordx4 v[116:119], v8, s[20:23], s54 offen
  v_lshl_add_u32 v39, v39, 7, v12
  ds_read_u16 v157, v31 offset:2050
  v_lshl_add_u32 v43, v43, 7, v12
  ds_read_u16 v158, v35 offset:2050
  v_lshl_add_u32 v47, v47, 7, v12
  ds_read_u16 v159, v39 offset:2050
  v_lshl_add_u32 v51, v51, 7, v12
  ds_read_u16 v160, v43 offset:2050
  buffer_load_dwordx4 v[120:123], v8, s[20:23], s55 offen
  v_lshl_add_u32 v55, v55, 7, v12
  ds_read_u16 v161, v47 offset:2050
  ds_read_u16 v162, v51 offset:2050
  ds_read_u16 v163, v55 offset:6146
  buffer_load_dwordx4 v[124:127], v10, s[20:23], 0 offen offset:512
  v_add_u32 v8, 1179648, v8
  v_add_u32 v10, 1179648, v10
  s_waitcnt lgkmcnt(15)
  v_lshl_or_b32 v164, v129, 16, v128
  v_lshl_or_b32 v165, v131, 16, v130
  v_lshl_or_b32 v166, v133, 16, v132
  v_lshl_or_b32 v167, v135, 16, v134
  ds_write_b128 v16, v[164:167] offset:0
  ds_write_b16 v17, v136 offset:0
  s_waitcnt lgkmcnt(15)
  v_lshl_or_b32 v168, v138, 16, v137
  v_lshl_or_b32 v169, v140, 16, v139
  v_lshl_or_b32 v170, v142, 16, v141
  v_lshl_or_b32 v171, v144, 16, v143
  ds_write_b128 v16, v[168:171] offset:1024
  ds_write_b16 v17, v145 offset:16
  s_waitcnt lgkmcnt(13)
  v_lshl_or_b32 v172, v147, 16, v146
  v_lshl_or_b32 v173, v149, 16, v148
  v_lshl_or_b32 v174, v151, 16, v150
  v_lshl_or_b32 v175, v153, 16, v152
  ds_write_b128 v16, v[172:175] offset:2048
  ds_write_b16 v17, v154 offset:32
  s_waitcnt lgkmcnt(6)
  v_lshl_or_b32 v176, v156, 16, v155
  v_lshl_or_b32 v177, v158, 16, v157
  v_lshl_or_b32 v178, v160, 16, v159
  v_lshl_or_b32 v179, v162, 16, v161
  ds_write_b128 v16, v[176:179] offset:3072
  ds_write_b16 v17, v163 offset:48
  s_waitcnt vmcnt(9)
  v_lshl_add_u32 v56, v56, 7, v12
  v_lshl_add_u32 v60, v60, 7, v12
  v_lshl_add_u32 v64, v64, 7, v12
  ds_read_u16 v128, v56 offset:0
  v_lshl_add_u32 v68, v68, 7, v12
  ds_read_u16 v129, v60 offset:0
  buffer_load_dwordx4 v[20:23], v8, s[20:23], s48 offen
  v_lshl_add_u32 v72, v72, 7, v12
  ds_read_u16 v130, v64 offset:0
  v_lshl_add_u32 v76, v76, 7, v12
  ds_read_u16 v131, v68 offset:0
  v_lshl_add_u32 v80, v80, 7, v12
  ds_read_u16 v132, v72 offset:0
  v_lshl_add_u32 v84, v84, 7, v12
  ds_read_u16 v133, v76 offset:0
  buffer_load_dwordx4 v[24:27], v8, s[20:23], s49 offen
  v_lshl_add_u32 v88, v88, 7, v12
  ds_read_u16 v134, v80 offset:0
  ds_read_u16 v135, v84 offset:0
  ds_read_u16 v136, v88 offset:4096
  v_lshl_add_u32 v57, v57, 7, v12
  v_lshl_add_u32 v61, v61, 7, v12
  v_lshl_add_u32 v65, v65, 7, v12
  ds_read_u16 v137, v57 offset:2
  v_lshl_add_u32 v69, v69, 7, v12
  ds_read_u16 v138, v61 offset:2
  buffer_load_dwordx4 v[28:31], v8, s[20:23], s50 offen
  v_lshl_add_u32 v73, v73, 7, v12
  ds_read_u16 v139, v65 offset:2
  v_lshl_add_u32 v77, v77, 7, v12
  ds_read_u16 v140, v69 offset:2
  v_lshl_add_u32 v81, v81, 7, v12
  ds_read_u16 v141, v73 offset:2
  v_lshl_add_u32 v85, v85, 7, v12
  ds_read_u16 v142, v77 offset:2
  buffer_load_dwordx4 v[32:35], v8, s[20:23], s51 offen
  v_lshl_add_u32 v89, v89, 7, v12
  ds_read_u16 v143, v81 offset:2
  ds_read_u16 v144, v85 offset:2
  ds_read_u16 v145, v89 offset:4098
  s_waitcnt lgkmcnt(15)
  s_barrier
  v_lshl_add_u32 v58, v58, 7, v12
  v_lshl_add_u32 v62, v62, 7, v12
  v_lshl_add_u32 v66, v66, 7, v12
  ds_read_u16 v146, v58 offset:2048
  v_lshl_add_u32 v70, v70, 7, v12
  ds_read_u16 v147, v62 offset:2048
  buffer_load_dwordx4 v[36:39], v8, s[20:23], s52 offen
  v_lshl_add_u32 v74, v74, 7, v12
  ds_read_u16 v148, v66 offset:2048
  v_lshl_add_u32 v78, v78, 7, v12
  ds_read_u16 v149, v70 offset:2048
  v_lshl_add_u32 v82, v82, 7, v12
  ds_read_u16 v150, v74 offset:2048
  v_lshl_add_u32 v86, v86, 7, v12
  ds_read_u16 v151, v78 offset:2048
  buffer_load_dwordx4 v[40:43], v8, s[20:23], s53 offen
  v_lshl_add_u32 v90, v90, 7, v12
  ds_read_u16 v152, v82 offset:2048
  ds_read_u16 v153, v86 offset:2048
  ds_read_u16 v154, v90 offset:6144
  v_lshl_add_u32 v59, v59, 7, v12
  v_lshl_add_u32 v63, v63, 7, v12
  v_lshl_add_u32 v67, v67, 7, v12
  ds_read_u16 v155, v59 offset:2050
  v_lshl_add_u32 v71, v71, 7, v12
  ds_read_u16 v156, v63 offset:2050
  buffer_load_dwordx4 v[44:47], v8, s[20:23], s54 offen
  v_lshl_add_u32 v75, v75, 7, v12
  ds_read_u16 v157, v67 offset:2050
  v_lshl_add_u32 v79, v79, 7, v12
  ds_read_u16 v158, v71 offset:2050
  v_lshl_add_u32 v83, v83, 7, v12
  ds_read_u16 v159, v75 offset:2050
  v_lshl_add_u32 v87, v87, 7, v12
  ds_read_u16 v160, v79 offset:2050
  buffer_load_dwordx4 v[48:51], v8, s[20:23], s55 offen
  v_lshl_add_u32 v91, v91, 7, v12
  ds_read_u16 v161, v83 offset:2050
  ds_read_u16 v162, v87 offset:2050
  ds_read_u16 v163, v91 offset:6146
  buffer_load_dwordx4 v[52:55], v10, s[20:23], 0 offen offset:512
  v_add_u32 v8, 1179648, v8
  v_add_u32 v10, 1179648, v10
  s_waitcnt lgkmcnt(15)
  v_lshl_or_b32 v164, v129, 16, v128
  v_lshl_or_b32 v165, v131, 16, v130
  v_lshl_or_b32 v166, v133, 16, v132
  v_lshl_or_b32 v167, v135, 16, v134
  ds_write_b128 v16, v[164:167] offset:18432
  ds_write_b16 v17, v136 offset:18432
  s_waitcnt lgkmcnt(15)
  v_lshl_or_b32 v168, v138, 16, v137
  v_lshl_or_b32 v169, v140, 16, v139
  v_lshl_or_b32 v170, v142, 16, v141
  v_lshl_or_b32 v171, v144, 16, v143
  ds_write_b128 v16, v[168:171] offset:19456
  ds_write_b16 v17, v145 offset:18448
  s_waitcnt lgkmcnt(13)
  v_lshl_or_b32 v172, v147, 16, v146
  v_lshl_or_b32 v173, v149, 16, v148
  v_lshl_or_b32 v174, v151, 16, v150
  v_lshl_or_b32 v175, v153, 16, v152
  ds_write_b128 v16, v[172:175] offset:20480
  ds_write_b16 v17, v154 offset:18464
  s_waitcnt lgkmcnt(6)
  v_lshl_or_b32 v176, v156, 16, v155
  v_lshl_or_b32 v177, v158, 16, v157
  v_lshl_or_b32 v178, v160, 16, v159
  v_lshl_or_b32 v179, v162, 16, v161
  ds_write_b128 v16, v[176:179] offset:21504
  ds_write_b16 v17, v163 offset:18480
  s_waitcnt vmcnt(9)
  v_lshl_add_u32 v92, v92, 7, v12
  v_lshl_add_u32 v96, v96, 7, v12
  v_lshl_add_u32 v100, v100, 7, v12
  ds_read_u16 v128, v92 offset:0
  v_lshl_add_u32 v104, v104, 7, v12
  ds_read_u16 v129, v96 offset:0
  buffer_load_dwordx4 v[56:59], v8, s[20:23], s48 offen
  v_lshl_add_u32 v108, v108, 7, v12
  ds_read_u16 v130, v100 offset:0
  v_lshl_add_u32 v112, v112, 7, v12
  ds_read_u16 v131, v104 offset:0
  v_lshl_add_u32 v116, v116, 7, v12
  ds_read_u16 v132, v108 offset:0
  v_lshl_add_u32 v120, v120, 7, v12
  ds_read_u16 v133, v112 offset:0
  buffer_load_dwordx4 v[60:63], v8, s[20:23], s49 offen
  v_lshl_add_u32 v124, v124, 7, v12
  ds_read_u16 v134, v116 offset:0
  ds_read_u16 v135, v120 offset:0
  ds_read_u16 v136, v124 offset:4096
  v_lshl_add_u32 v93, v93, 7, v12
  v_lshl_add_u32 v97, v97, 7, v12
  v_lshl_add_u32 v101, v101, 7, v12
  ds_read_u16 v137, v93 offset:2
  v_lshl_add_u32 v105, v105, 7, v12
  ds_read_u16 v138, v97 offset:2
  buffer_load_dwordx4 v[64:67], v8, s[20:23], s50 offen
  v_lshl_add_u32 v109, v109, 7, v12
  ds_read_u16 v139, v101 offset:2
  v_lshl_add_u32 v113, v113, 7, v12
  ds_read_u16 v140, v105 offset:2
  v_lshl_add_u32 v117, v117, 7, v12
  ds_read_u16 v141, v109 offset:2
  v_lshl_add_u32 v121, v121, 7, v12
  ds_read_u16 v142, v113 offset:2
  buffer_load_dwordx4 v[68:71], v8, s[20:23], s51 offen
  v_lshl_add_u32 v125, v125, 7, v12
  ds_read_u16 v143, v117 offset:2
  ds_read_u16 v144, v121 offset:2
  ds_read_u16 v145, v125 offset:4098
  s_waitcnt lgkmcnt(15)
  s_barrier
  v_lshl_add_u32 v94, v94, 7, v12
  v_lshl_add_u32 v98, v98, 7, v12
  v_lshl_add_u32 v102, v102, 7, v12
  ds_read_u16 v146, v94 offset:2048
  v_lshl_add_u32 v106, v106, 7, v12
  ds_read_u16 v147, v98 offset:2048
  buffer_load_dwordx4 v[72:75], v8, s[20:23], s52 offen
  v_lshl_add_u32 v110, v110, 7, v12
  ds_read_u16 v148, v102 offset:2048
  v_lshl_add_u32 v114, v114, 7, v12
  ds_read_u16 v149, v106 offset:2048
  v_lshl_add_u32 v118, v118, 7, v12
  ds_read_u16 v150, v110 offset:2048
  v_lshl_add_u32 v122, v122, 7, v12
  ds_read_u16 v151, v114 offset:2048
  buffer_load_dwordx4 v[76:79], v8, s[20:23], s53 offen
  v_lshl_add_u32 v126, v126, 7, v12
  ds_read_u16 v152, v118 offset:2048
  ds_read_u16 v153, v122 offset:2048
  ds_read_u16 v154, v126 offset:6144
  v_lshl_add_u32 v95, v95, 7, v12
  v_lshl_add_u32 v99, v99, 7, v12
  v_lshl_add_u32 v103, v103, 7, v12
  ds_read_u16 v155, v95 offset:2050
  v_lshl_add_u32 v107, v107, 7, v12
  ds_read_u16 v156, v99 offset:2050
  buffer_load_dwordx4 v[80:83], v8, s[20:23], s54 offen
  v_lshl_add_u32 v111, v111, 7, v12
  ds_read_u16 v157, v103 offset:2050
  v_lshl_add_u32 v115, v115, 7, v12
  ds_read_u16 v158, v107 offset:2050
  v_lshl_add_u32 v119, v119, 7, v12
  ds_read_u16 v159, v111 offset:2050
  v_lshl_add_u32 v123, v123, 7, v12
  ds_read_u16 v160, v115 offset:2050
  buffer_load_dwordx4 v[84:87], v8, s[20:23], s55 offen
  v_lshl_add_u32 v127, v127, 7, v12
  ds_read_u16 v161, v119 offset:2050
  ds_read_u16 v162, v123 offset:2050
  ds_read_u16 v163, v127 offset:6146
  buffer_load_dwordx4 v[88:91], v10, s[20:23], 0 offen offset:512
  v_add_u32 v8, 1179648, v8
  v_add_u32 v10, 1179648, v10
  s_waitcnt lgkmcnt(15)
  v_lshl_or_b32 v164, v129, 16, v128
  v_lshl_or_b32 v165, v131, 16, v130
  v_lshl_or_b32 v166, v133, 16, v132
  v_lshl_or_b32 v167, v135, 16, v134
  ds_write_b128 v16, v[164:167] offset:36864
  ds_write_b16 v17, v136 offset:36864
  s_waitcnt lgkmcnt(15)
  v_lshl_or_b32 v168, v138, 16, v137
  v_lshl_or_b32 v169, v140, 16, v139
  v_lshl_or_b32 v170, v142, 16, v141
  v_lshl_or_b32 v171, v144, 16, v143
  ds_write_b128 v16, v[168:171] offset:37888
  ds_write_b16 v17, v145 offset:36880
  s_waitcnt lgkmcnt(13)
  v_lshl_or_b32 v172, v147, 16, v146
  v_lshl_or_b32 v173, v149, 16, v148
  v_lshl_or_b32 v174, v151, 16, v150
  v_lshl_or_b32 v175, v153, 16, v152
  ds_write_b128 v16, v[172:175] offset:38912
  ds_write_b16 v17, v154 offset:36896
  s_waitcnt lgkmcnt(6)
  v_lshl_or_b32 v176, v156, 16, v155
  v_lshl_or_b32 v177, v158, 16, v157
  v_lshl_or_b32 v178, v160, 16, v159
  v_lshl_or_b32 v179, v162, 16, v161
  ds_write_b128 v16, v[176:179] offset:39936
  ds_write_b16 v17, v163 offset:36912
  s_waitcnt vmcnt(9)
  v_lshl_add_u32 v20, v20, 7, v12
  v_lshl_add_u32 v24, v24, 7, v12
  v_lshl_add_u32 v28, v28, 7, v12
  ds_read_u16 v128, v20 offset:0
  v_lshl_add_u32 v32, v32, 7, v12
  ds_read_u16 v129, v24 offset:0
  buffer_load_dwordx4 v[92:95], v8, s[20:23], s48 offen
  v_lshl_add_u32 v36, v36, 7, v12
  ds_read_u16 v130, v28 offset:0
  v_lshl_add_u32 v40, v40, 7, v12
  ds_read_u16 v131, v32 offset:0
  v_lshl_add_u32 v44, v44, 7, v12
  ds_read_u16 v132, v36 offset:0
  v_lshl_add_u32 v48, v48, 7, v12
  ds_read_u16 v133, v40 offset:0
  buffer_load_dwordx4 v[96:99], v8, s[20:23], s49 offen
  v_lshl_add_u32 v52, v52, 7, v12
  ds_read_u16 v134, v44 offset:0
  ds_read_u16 v135, v48 offset:0
  ds_read_u16 v136, v52 offset:4096
  v_lshl_add_u32 v21, v21, 7, v12
  v_lshl_add_u32 v25, v25, 7, v12
  v_lshl_add_u32 v29, v29, 7, v12
  ds_read_u16 v137, v21 offset:2
  v_lshl_add_u32 v33, v33, 7, v12
  ds_read_u16 v138, v25 offset:2
  buffer_load_dwordx4 v[100:103], v8, s[20:23], s50 offen
  v_lshl_add_u32 v37, v37, 7, v12
  ds_read_u16 v139, v29 offset:2
  v_lshl_add_u32 v41, v41, 7, v12
  ds_read_u16 v140, v33 offset:2
  v_lshl_add_u32 v45, v45, 7, v12
  ds_read_u16 v141, v37 offset:2
  v_lshl_add_u32 v49, v49, 7, v12
  ds_read_u16 v142, v41 offset:2
  buffer_load_dwordx4 v[104:107], v8, s[20:23], s51 offen
  v_lshl_add_u32 v53, v53, 7, v12
  ds_read_u16 v143, v45 offset:2
  ds_read_u16 v144, v49 offset:2
  ds_read_u16 v145, v53 offset:4098
  s_waitcnt lgkmcnt(15)
  s_barrier
  v_lshl_add_u32 v22, v22, 7, v12
  v_lshl_add_u32 v26, v26, 7, v12
  v_lshl_add_u32 v30, v30, 7, v12
  ds_read_u16 v146, v22 offset:2048
  v_lshl_add_u32 v34, v34, 7, v12
  ds_read_u16 v147, v26 offset:2048
  buffer_load_dwordx4 v[108:111], v8, s[20:23], s52 offen
  v_lshl_add_u32 v38, v38, 7, v12
  ds_read_u16 v148, v30 offset:2048
  v_lshl_add_u32 v42, v42, 7, v12
  ds_read_u16 v149, v34 offset:2048
  v_lshl_add_u32 v46, v46, 7, v12
  ds_read_u16 v150, v38 offset:2048
  v_lshl_add_u32 v50, v50, 7, v12
  ds_read_u16 v151, v42 offset:2048
  buffer_load_dwordx4 v[112:115], v8, s[20:23], s53 offen
  v_lshl_add_u32 v54, v54, 7, v12
  ds_read_u16 v152, v46 offset:2048
  ds_read_u16 v153, v50 offset:2048
  ds_read_u16 v154, v54 offset:6144
  v_lshl_add_u32 v23, v23, 7, v12
  v_lshl_add_u32 v27, v27, 7, v12
  v_lshl_add_u32 v31, v31, 7, v12
  ds_read_u16 v155, v23 offset:2050
  v_lshl_add_u32 v35, v35, 7, v12
  ds_read_u16 v156, v27 offset:2050
  buffer_load_dwordx4 v[116:119], v8, s[20:23], s54 offen
  v_lshl_add_u32 v39, v39, 7, v12
  ds_read_u16 v157, v31 offset:2050
  v_lshl_add_u32 v43, v43, 7, v12
  ds_read_u16 v158, v35 offset:2050
  v_lshl_add_u32 v47, v47, 7, v12
  ds_read_u16 v159, v39 offset:2050
  v_lshl_add_u32 v51, v51, 7, v12
  ds_read_u16 v160, v43 offset:2050
  buffer_load_dwordx4 v[120:123], v8, s[20:23], s55 offen
  v_lshl_add_u32 v55, v55, 7, v12
  ds_read_u16 v161, v47 offset:2050
  ds_read_u16 v162, v51 offset:2050
  ds_read_u16 v163, v55 offset:6146
  buffer_load_dwordx4 v[124:127], v10, s[20:23], 0 offen offset:512
  v_add_u32 v8, 1179648, v8
  v_add_u32 v10, 1179648, v10
  s_waitcnt lgkmcnt(15)
  v_lshl_or_b32 v164, v129, 16, v128
  v_lshl_or_b32 v165, v131, 16, v130
  v_lshl_or_b32 v166, v133, 16, v132
  v_lshl_or_b32 v167, v135, 16, v134
  ds_write_b128 v16, v[164:167] offset:0
  ds_write_b16 v17, v136 offset:0
  s_waitcnt lgkmcnt(15)
  v_lshl_or_b32 v168, v138, 16, v137
  v_lshl_or_b32 v169, v140, 16, v139
  v_lshl_or_b32 v170, v142, 16, v141
  v_lshl_or_b32 v171, v144, 16, v143
  ds_write_b128 v16, v[168:171] offset:1024
  ds_write_b16 v17, v145 offset:16
  s_waitcnt lgkmcnt(13)
  v_lshl_or_b32 v172, v147, 16, v146
  v_lshl_or_b32 v173, v149, 16, v148
  v_lshl_or_b32 v174, v151, 16, v150
  v_lshl_or_b32 v175, v153, 16, v152
  ds_write_b128 v16, v[172:175] offset:2048
  ds_write_b16 v17, v154 offset:32
  s_waitcnt lgkmcnt(6)
  v_lshl_or_b32 v176, v156, 16, v155
  v_lshl_or_b32 v177, v158, 16, v157
  v_lshl_or_b32 v178, v160, 16, v159
  v_lshl_or_b32 v179, v162, 16, v161
  ds_write_b128 v16, v[176:179] offset:3072
  ds_write_b16 v17, v163 offset:48
  s_waitcnt vmcnt(9)
  v_lshl_add_u32 v56, v56, 7, v12
  v_lshl_add_u32 v60, v60, 7, v12
  v_lshl_add_u32 v64, v64, 7, v12
  ds_read_u16 v128, v56 offset:0
  v_lshl_add_u32 v68, v68, 7, v12
  ds_read_u16 v129, v60 offset:0
  v_lshl_add_u32 v72, v72, 7, v12
  ds_read_u16 v130, v64 offset:0
  v_lshl_add_u32 v76, v76, 7, v12
  ds_read_u16 v131, v68 offset:0
  v_lshl_add_u32 v80, v80, 7, v12
  ds_read_u16 v132, v72 offset:0
  v_lshl_add_u32 v84, v84, 7, v12
  ds_read_u16 v133, v76 offset:0
  v_lshl_add_u32 v88, v88, 7, v12
  ds_read_u16 v134, v80 offset:0
  ds_read_u16 v135, v84 offset:0
  ds_read_u16 v136, v88 offset:4096
  v_lshl_add_u32 v57, v57, 7, v12
  v_lshl_add_u32 v61, v61, 7, v12
  v_lshl_add_u32 v65, v65, 7, v12
  ds_read_u16 v137, v57 offset:2
  v_lshl_add_u32 v69, v69, 7, v12
  ds_read_u16 v138, v61 offset:2
  v_lshl_add_u32 v73, v73, 7, v12
  ds_read_u16 v139, v65 offset:2
  v_lshl_add_u32 v77, v77, 7, v12
  ds_read_u16 v140, v69 offset:2
  v_lshl_add_u32 v81, v81, 7, v12
  ds_read_u16 v141, v73 offset:2
  v_lshl_add_u32 v85, v85, 7, v12
  ds_read_u16 v142, v77 offset:2
  v_lshl_add_u32 v89, v89, 7, v12
  ds_read_u16 v143, v81 offset:2
  ds_read_u16 v144, v85 offset:2
  ds_read_u16 v145, v89 offset:4098
  s_waitcnt lgkmcnt(15)
  s_barrier
  v_lshl_add_u32 v58, v58, 7, v12
  v_lshl_add_u32 v62, v62, 7, v12
  v_lshl_add_u32 v66, v66, 7, v12
  ds_read_u16 v146, v58 offset:2048
  v_lshl_add_u32 v70, v70, 7, v12
  ds_read_u16 v147, v62 offset:2048
  v_lshl_add_u32 v74, v74, 7, v12
  ds_read_u16 v148, v66 offset:2048
  v_lshl_add_u32 v78, v78, 7, v12
  ds_read_u16 v149, v70 offset:2048
  v_lshl_add_u32 v82, v82, 7, v12
  ds_read_u16 v150, v74 offset:2048
  v_lshl_add_u32 v86, v86, 7, v12
  ds_read_u16 v151, v78 offset:2048
  v_lshl_add_u32 v90, v90, 7, v12
  ds_read_u16 v152, v82 offset:2048
  ds_read_u16 v153, v86 offset:2048
  ds_read_u16 v154, v90 offset:6144
  v_lshl_add_u32 v59, v59, 7, v12
  v_lshl_add_u32 v63, v63, 7, v12
  v_lshl_add_u32 v67, v67, 7, v12
  ds_read_u16 v155, v59 offset:2050
  v_lshl_add_u32 v71, v71, 7, v12
  ds_read_u16 v156, v63 offset:2050
  v_lshl_add_u32 v75, v75, 7, v12
  ds_read_u16 v157, v67 offset:2050
  v_lshl_add_u32 v79, v79, 7, v12
  ds_read_u16 v158, v71 offset:2050
  v_lshl_add_u32 v83, v83, 7, v12
  ds_read_u16 v159, v75 offset:2050
  v_lshl_add_u32 v87, v87, 7, v12
  ds_read_u16 v160, v79 offset:2050
  v_lshl_add_u32 v91, v91, 7, v12
  ds_read_u16 v161, v83 offset:2050
  ds_read_u16 v162, v87 offset:2050
  ds_read_u16 v163, v91 offset:6146
  s_waitcnt lgkmcnt(15)
  v_lshl_or_b32 v164, v129, 16, v128
  v_lshl_or_b32 v165, v131, 16, v130
  v_lshl_or_b32 v166, v133, 16, v132
  v_lshl_or_b32 v167, v135, 16, v134
  ds_write_b128 v16, v[164:167] offset:18432
  ds_write_b16 v17, v136 offset:18432
  s_waitcnt lgkmcnt(15)
  v_lshl_or_b32 v168, v138, 16, v137
  v_lshl_or_b32 v169, v140, 16, v139
  v_lshl_or_b32 v170, v142, 16, v141
  v_lshl_or_b32 v171, v144, 16, v143
  ds_write_b128 v16, v[168:171] offset:19456
  ds_write_b16 v17, v145 offset:18448
  s_waitcnt lgkmcnt(13)
  v_lshl_or_b32 v172, v147, 16, v146
  v_lshl_or_b32 v173, v149, 16, v148
  v_lshl_or_b32 v174, v151, 16, v150
  v_lshl_or_b32 v175, v153, 16, v152
  ds_write_b128 v16, v[172:175] offset:20480
  ds_write_b16 v17, v154 offset:18464
  s_waitcnt lgkmcnt(6)
  v_lshl_or_b32 v176, v156, 16, v155
  v_lshl_or_b32 v177, v158, 16, v157
  v_lshl_or_b32 v178, v160, 16, v159
  v_lshl_or_b32 v179, v162, 16, v161
  ds_write_b128 v16, v[176:179] offset:21504
  ds_write_b16 v17, v163 offset:18480
  s_waitcnt vmcnt(0)
  v_lshl_add_u32 v92, v92, 7, v12
  v_lshl_add_u32 v96, v96, 7, v12
  v_lshl_add_u32 v100, v100, 7, v12
  ds_read_u16 v128, v92 offset:0
  v_lshl_add_u32 v104, v104, 7, v12
  ds_read_u16 v129, v96 offset:0
  v_lshl_add_u32 v108, v108, 7, v12
  ds_read_u16 v130, v100 offset:0
  v_lshl_add_u32 v112, v112, 7, v12
  ds_read_u16 v131, v104 offset:0
  v_lshl_add_u32 v116, v116, 7, v12
  ds_read_u16 v132, v108 offset:0
  v_lshl_add_u32 v120, v120, 7, v12
  ds_read_u16 v133, v112 offset:0
  v_lshl_add_u32 v124, v124, 7, v12
  ds_read_u16 v134, v116 offset:0
  ds_read_u16 v135, v120 offset:0
  ds_read_u16 v136, v124 offset:4096
  v_lshl_add_u32 v93, v93, 7, v12
  v_lshl_add_u32 v97, v97, 7, v12
  v_lshl_add_u32 v101, v101, 7, v12
  ds_read_u16 v137, v93 offset:2
  v_lshl_add_u32 v105, v105, 7, v12
  ds_read_u16 v138, v97 offset:2
  v_lshl_add_u32 v109, v109, 7, v12
  ds_read_u16 v139, v101 offset:2
  v_lshl_add_u32 v113, v113, 7, v12
  ds_read_u16 v140, v105 offset:2
  v_lshl_add_u32 v117, v117, 7, v12
  ds_read_u16 v141, v109 offset:2
  v_lshl_add_u32 v121, v121, 7, v12
  ds_read_u16 v142, v113 offset:2
  v_lshl_add_u32 v125, v125, 7, v12
  ds_read_u16 v143, v117 offset:2
  ds_read_u16 v144, v121 offset:2
  ds_read_u16 v145, v125 offset:4098
  s_waitcnt lgkmcnt(15)
  s_barrier
  v_lshl_add_u32 v94, v94, 7, v12
  v_lshl_add_u32 v98, v98, 7, v12
  v_lshl_add_u32 v102, v102, 7, v12
  ds_read_u16 v146, v94 offset:2048
  v_lshl_add_u32 v106, v106, 7, v12
  ds_read_u16 v147, v98 offset:2048
  v_lshl_add_u32 v110, v110, 7, v12
  ds_read_u16 v148, v102 offset:2048
  v_lshl_add_u32 v114, v114, 7, v12
  ds_read_u16 v149, v106 offset:2048
  v_lshl_add_u32 v118, v118, 7, v12
  ds_read_u16 v150, v110 offset:2048
  v_lshl_add_u32 v122, v122, 7, v12
  ds_read_u16 v151, v114 offset:2048
  v_lshl_add_u32 v126, v126, 7, v12
  ds_read_u16 v152, v118 offset:2048
  ds_read_u16 v153, v122 offset:2048
  ds_read_u16 v154, v126 offset:6144
  v_lshl_add_u32 v95, v95, 7, v12
  v_lshl_add_u32 v99, v99, 7, v12
  v_lshl_add_u32 v103, v103, 7, v12
  ds_read_u16 v155, v95 offset:2050
  v_lshl_add_u32 v107, v107, 7, v12
  ds_read_u16 v156, v99 offset:2050
  v_lshl_add_u32 v111, v111, 7, v12
  ds_read_u16 v157, v103 offset:2050
  v_lshl_add_u32 v115, v115, 7, v12
  ds_read_u16 v158, v107 offset:2050
  v_lshl_add_u32 v119, v119, 7, v12
  ds_read_u16 v159, v111 offset:2050
  v_lshl_add_u32 v123, v123, 7, v12
  ds_read_u16 v160, v115 offset:2050
  v_lshl_add_u32 v127, v127, 7, v12
  ds_read_u16 v161, v119 offset:2050
  ds_read_u16 v162, v123 offset:2050
  ds_read_u16 v163, v127 offset:6146
  s_waitcnt lgkmcnt(15)
  v_lshl_or_b32 v164, v129, 16, v128
  v_lshl_or_b32 v165, v131, 16, v130
  v_lshl_or_b32 v166, v133, 16, v132
  v_lshl_or_b32 v167, v135, 16, v134
  ds_write_b128 v16, v[164:167] offset:36864
  ds_write_b16 v17, v136 offset:36864
  s_waitcnt lgkmcnt(15)
  v_lshl_or_b32 v168, v138, 16, v137
  v_lshl_or_b32 v169, v140, 16, v139
  v_lshl_or_b32 v170, v142, 16, v141
  v_lshl_or_b32 v171, v144, 16, v143
  ds_write_b128 v16, v[168:171] offset:37888
  ds_write_b16 v17, v145 offset:36880
  s_waitcnt lgkmcnt(13)
  v_lshl_or_b32 v172, v147, 16, v146
  v_lshl_or_b32 v173, v149, 16, v148
  v_lshl_or_b32 v174, v151, 16, v150
  v_lshl_or_b32 v175, v153, 16, v152
  ds_write_b128 v16, v[172:175] offset:38912
  ds_write_b16 v17, v154 offset:36896
  s_waitcnt lgkmcnt(6)
  v_lshl_or_b32 v176, v156, 16, v155
  v_lshl_or_b32 v177, v158, 16, v157
  v_lshl_or_b32 v178, v160, 16, v159
  v_lshl_or_b32 v179, v162, 16, v161
  ds_write_b128 v16, v[176:179] offset:39936
  ds_write_b16 v17, v163 offset:36912
  s_waitcnt lgkmcnt(0)
  s_barrier
L_end:
  s_endpgm
.section .rodata,"a"
.p2align 6
.amdhsa_kernel standalone__weight_only_int_squeezellm__prompt_kernel
  .amdhsa_next_free_vgpr 256
  .amdhsa_next_free_sgpr 72
  .amdhsa_accum_offset 256
  .amdhsa_group_segment_fixed_size 0
  .amdhsa_kernarg_size 48
  .amdhsa_user_sgpr_count 2
  .amdhsa_user_sgpr_kernarg_segment_ptr 1
  .amdhsa_system_sgpr_workgroup_id_x 1
.end_amdhsa_kernel
```
